```python
import torch

def _softmax(x, axis=-1):
    return torch.softmax(x, dim=axis)
def _gelu(x):
    return torch.nn.functional.gelu(x, approximate="tanh")
def _silu(x):
    return torch.nn.functional.silu(x)
def _sigmoid(x):
    return torch.sigmoid(x)
def _layernorm(x, axis=-1, eps=1e-5):
    m = x.mean(dim=axis, keepdim=True)
    v = x.var(dim=axis, keepdim=True, unbiased=False)
    return (x - m) / torch.sqrt(v + eps)
def _scatter_add(tgt, idx, src, axis=0):
    return tgt.clone().index_add_(axis, idx, src)
def _segment_sum(src, seg, n):
    out = torch.zeros((n,) + src.shape[1:], dtype=src.dtype)
    return out.index_add_(0, seg, src)
def _pad(x, pw):
    flat = tuple(v for pair in reversed(pw) for v in pair)
    return torch.nn.functional.pad(x, flat)

kernel_name = 'standalone__mha_softmax__near_ridge'

def setup_inputs():

    _w = (lambda a: (lambda t: t.to(torch.bfloat16) if t.is_floating_point() else t)(torch.as_tensor(a)))
    B, H, Sq, Sk, D = 16, 32, 496, 512, 128
    return {
        "q": _w((lambda *s: torch.randn(*s, dtype=torch.bfloat16) * 0.8)(B, H, Sq, D)),
        "k": _w((lambda *s: torch.randn(*s, dtype=torch.bfloat16) * 0.8)(B, H, Sk, D)),
        "v": _w((lambda *s: torch.randn(*s, dtype=torch.bfloat16) * 0.05)(B, H, Sk, D)),
    }

def reference(q, k, v):
    scale = q.shape[-1] ** -0.5
    scores = torch.einsum("bhqd,bhkd->bhqk", q, k) * scale
    p = _softmax(scores, axis=-1)
    return torch.einsum("bhqk,bhkd->bhqd", p, v)
```

```asm
; @launch grid=(256,1,1) block=(256,1,1) lds=163840
.amdgcn_target "amdgcn-amd-amdhsa--gfx950"
.text
.globl standalone__mha_softmax__near_ridge_kernel
.p2align 8
.type standalone__mha_softmax__near_ridge_kernel,@function
standalone__mha_softmax__near_ridge_kernel:
    s_cmp_ge_u32 s2, 256
    s_cbranch_scc1 L_end
    s_load_dwordx4 s[52:55], s[0:1], 0
    s_load_dwordx4 s[56:59], s[0:1], 16
    v_lshrrev_b32 v208, 6, v0
    v_and_b32 v209, 63, v0
    s_nop 0
    v_readfirstlane_b32 s24, v208
    v_lshrrev_b32 v213, 4, v209
    v_and_b32 v214, 15, v209
    v_lshlrev_b32 v215, 8, v213
    v_add_u32 v216, 0, v213
    v_xor_b32 v216, v216, v214
    v_lshl_add_u32 v184, v216, 4, v215
    v_add_u32 v216, 4, v213
    v_xor_b32 v216, v216, v214
    v_lshl_add_u32 v185, v216, 4, v215
    v_add_u32 v216, 8, v213
    v_xor_b32 v216, v216, v214
    v_lshl_add_u32 v186, v216, 4, v215
    v_add_u32 v216, 12, v213
    v_xor_b32 v216, v216, v214
    v_lshl_add_u32 v187, v216, 4, v215
    v_lshlrev_b32 v216, 2, v213
    v_xor_b32 v216, v216, v214
    v_lshl_add_u32 v188, v216, 4, v215
    s_getpc_b64 s[46:47]
L_pc:
    s_lshr_b32 s40, s2, 3
    s_lshl_b32 s40, s40, 2
    s_add_u32 s40, s40, s24
    s_mul_i32 s40, s40, 3
    v_min_u32 v252, 2, v209
    v_add_u32 v252, s40, v252
    v_lshlrev_b32 v252, 7, v252
    v_min_u32 v252, L_slow - L_pc, v252
    global_load_dword v251, v252, s[46:47]
    s_and_b32 s40, s2, 7
    s_lshr_b32 s41, s2, 3
    s_and_b32 s42, s41, 1
    s_lshr_b32 s41, s41, 1
    s_lshl_b32 s40, s40, 6
    s_add_u32 s48, s40, s41
    s_lshl_b32 s43, s42, 8
    s_lshl_b32 s44, s24, 6
    s_add_u32 s49, s43, s44
    s_cmp_eq_u32 s49, 448
    s_cselect_b32 s35, 0, -1
    s_lshl_b32 s45, s24, 14
    s_add_u32 s34, s45, 98304
    s_lshl_b32 s50, s24, 12
    s_mov_b32 s36, 4096
    s_mov_b32 s37, 8192
    s_mov_b32 s38, 12288
    s_mov_b32 s31, 0x3e0293ee
    s_mov_b32 s32, 0x4b800000
    s_mov_b32 s33, 0
    s_mov_b32 s30, 0
    s_waitcnt lgkmcnt(0)
    s_mov_b32 s8, s54
    s_mov_b32 s9, s55
    s_mov_b32 s10, 67108864
    s_mov_b32 s11, 0x20000
    s_mov_b32 s12, s56
    s_mov_b32 s13, s57
    s_mov_b32 s14, 67108864
    s_mov_b32 s15, 0x20000
    s_mov_b32 s46, s48
    s_mul_i32 s40, s46, 126976
    s_lshl_b32 s41, s49, 8
    s_add_u32 s40, s40, s41
    s_add_u32 s16, s52, s40
    s_addc_u32 s17, s53, 0
    s_mov_b32 s18, 16384
    s_mov_b32 s19, 0x20000
    s_mul_i32 s40, s48, 126976
    s_add_u32 s40, s40, s41
    s_add_u32 s20, s58, s40
    s_addc_u32 s21, s59, 0
    s_sub_u32 s20, s20, 2031616
    s_subb_u32 s21, s21, 0
    s_mov_b32 s51, 1
    s_mov_b32 s22, 0
    s_mov_b32 s23, 0x20000
    s_lshl_b32 s3, s46, 17
    s_add_u32 s3, s3, s50
    s_mov_b32 s4, 0
    s_add_u32 s25, s3, s4
    s_mov_b32 s27, 0
    s_add_u32 m0, s50, 0
    s_nop 0
    buffer_load_dwordx4 v184, s[8:11], s25 offen nt lds
    s_add_u32 m0, s50, 49152
    s_nop 0
    buffer_load_dwordx4 v188, s[12:15], s25 offen nt lds
    s_mov_b32 m0, s34
    s_nop 0
    buffer_load_dwordx4 v184, s[16:19], 0 offen nt lds
    s_add_u32 m0, s50, 0
    s_nop 0
    buffer_load_dwordx4 v185, s[8:11], s25 offen offset:1024 nt lds
    s_add_u32 m0, s50, 49152
    s_nop 0
    buffer_load_dwordx4 v188, s[12:15], s25 offen offset:1024 nt lds
    s_mov_b32 m0, s34
    s_nop 0
    buffer_load_dwordx4 v185, s[16:19], 0 offen offset:1024 nt lds
    s_add_u32 m0, s50, 0
    s_nop 0
    buffer_load_dwordx4 v186, s[8:11], s25 offen offset:2048 nt lds
    s_add_u32 m0, s50, 49152
    s_nop 0
    buffer_load_dwordx4 v188, s[12:15], s25 offen offset:2048 nt lds
    s_mov_b32 m0, s34
    s_nop 0
    buffer_load_dwordx4 v186, s[16:19], 0 offen offset:2048 nt lds
    s_add_u32 m0, s50, 0
    s_nop 0
    buffer_load_dwordx4 v187, s[8:11], s25 offen offset:3072 nt lds
    s_add_u32 m0, s50, 49152
    s_nop 0
    buffer_load_dwordx4 v188, s[12:15], s25 offen offset:3072 nt lds
    s_mov_b32 m0, s34
    s_nop 0
    buffer_load_dwordx4 v187, s[16:19], 0 offen offset:3072 nt lds
    s_add_u32 s4, s4, 16384
    s_and_b32 s4, s4, 0x1ffff
    s_add_u32 s26, s3, s4
    s_add_u32 s4, s4, 16384
    s_and_b32 s4, s4, 0x1ffff
    s_add_u32 s5, s3, s4
    s_add_u32 m0, s34, 4096
    s_nop 0
    buffer_load_dwordx4 v184, s[16:19], s36 offen nt lds
    buffer_load_dwordx4 v185, s[16:19], s36 offen offset:1024 nt lds
    buffer_load_dwordx4 v186, s[16:19], s36 offen offset:2048 nt lds
    buffer_load_dwordx4 v187, s[16:19], s36 offen offset:3072 nt lds
    v_xor_b32 v215, v213, v214
    v_lshlrev_b32 v215, 4, v215
    v_lshl_add_u32 v215, v214, 8, v215
    v_xor_b32 v160, 0, v215
    v_xor_b32 v161, 64, v215
    v_xor_b32 v162, 128, v215
    v_xor_b32 v163, 192, v215
    v_add_u32 v164, s34, v160
    v_add_u32 v165, s34, v161
    v_add_u32 v166, s34, v162
    v_add_u32 v167, s34, v163
    v_bfe_u32 v216, v209, 2, 2
    v_lshl_add_u32 v217, v213, 2, v216
    v_lshlrev_b32 v217, 8, v217
    v_lshl_add_u32 v217, v216, 6, v217
    v_and_b32 v218, 3, v209
    v_lshl_add_u32 v217, v218, 4, v217
    v_xor_b32 v168, 0, v217
    v_add_u32 v168, 49152, v168
    v_xor_b32 v169, 64, v217
    v_add_u32 v169, 49152, v169
    v_xor_b32 v170, 128, v217
    v_add_u32 v170, 49152, v170
    v_xor_b32 v171, 192, v217
    v_add_u32 v171, 49152, v171
    v_lshlrev_b32 v190, 4, v209
    v_add_u32 v190, s34, v190
    s_cmp_eq_u32 s35, 0
    s_cselect_b32 s40, 0x7149f2ca, 0
    v_mov_b32 v253, s40
    v_and_b32 v217, 3, v209
    v_mov_b32 v216, 0x3f803f80
    v_cmp_eq_u32 vcc, 0, v217
    s_nop 1
    v_cndmask_b32 v216, 0, v216, vcc
    v_accvgpr_write_b32 a208, v216
    v_accvgpr_write_b32 a209, v216
    v_accvgpr_write_b32 a210, v216
    v_accvgpr_write_b32 a211, v216
    s_waitcnt vmcnt(4)
    s_barrier
    ds_read_b128 a[64:67], v160
    ds_read_b128 a[68:71], v161
    ds_read_b128 a[72:75], v162
    ds_read_b128 a[76:79], v163
    ds_read_b128 a[0:3], v164
    ds_read_b128 a[4:7], v165
    ds_read_b128 a[8:11], v166
    ds_read_b128 a[12:15], v167
    ds_read_b128 a[80:83], v160 offset:4096
    ds_read_b128 a[84:87], v161 offset:4096
    ds_read_b128 a[88:91], v162 offset:4096
    ds_read_b128 a[92:95], v163 offset:4096
    ds_read_b128 a[96:99], v160 offset:8192
    ds_read_b128 a[100:103], v161 offset:8192
    ds_read_b128 a[104:107], v162 offset:8192
    ds_read_b128 a[108:111], v163 offset:8192
    ds_read_b128 a[112:115], v160 offset:12288
    ds_read_b128 a[116:119], v161 offset:12288
    ds_read_b128 a[120:123], v162 offset:12288
    ds_read_b128 a[124:127], v163 offset:12288
    s_waitcnt lgkmcnt(12)
    v_mfma_f32_16x16x32_bf16 v[128:131], a[64:67], a[0:3], 0
    s_add_u32 m0, s34, 8192
    v_mfma_f32_16x16x32_bf16 v[128:131], a[68:71], a[4:7], v[128:131]
    s_add_u32 s4, s4, 16384
    buffer_load_dwordx4 v184, s[16:19], s37 offen nt lds
    v_mfma_f32_16x16x32_bf16 v[128:131], a[72:75], a[8:11], v[128:131]
    s_and_b32 s4, s4, 0x1ffff
    v_mfma_f32_16x16x32_bf16 v[128:131], a[76:79], a[12:15], v[128:131]
    s_waitcnt lgkmcnt(8)
    buffer_load_dwordx4 v185, s[16:19], s37 offen offset:1024 nt lds
    v_mfma_f32_16x16x32_bf16 v[132:135], a[80:83], a[0:3], 0
    v_mfma_f32_16x16x32_bf16 v[132:135], a[84:87], a[4:7], v[132:135]
    s_add_u32 s25, s3, s4
    buffer_load_dwordx4 v186, s[16:19], s37 offen offset:2048 nt lds
    v_mfma_f32_16x16x32_bf16 v[132:135], a[88:91], a[8:11], v[132:135]
    v_mfma_f32_16x16x32_bf16 v[132:135], a[92:95], a[12:15], v[132:135]
    s_waitcnt lgkmcnt(4)
    buffer_load_dwordx4 v187, s[16:19], s37 offen offset:3072 nt lds
    v_mfma_f32_16x16x32_bf16 v[136:139], a[96:99], a[0:3], 0
    v_max3_f32 v208, v128, v129, v130
    v_max_f32 v208, v208, v131
    s_and_b32 s18, s18, s35
    s_add_u32 m0, s34, 12288
    v_mfma_f32_16x16x32_bf16 v[136:139], a[100:103], a[4:7], v[136:139]
    s_add_u32 s39, s27, 16384
    buffer_load_dwordx4 v184, s[16:19], s38 offen nt lds
    v_mov_b32 v209, v208
    v_mfma_f32_16x16x32_bf16 v[136:139], a[104:107], a[8:11], v[136:139]
    v_mfma_f32_16x16x32_bf16 v[136:139], a[108:111], a[12:15], v[136:139]
    s_waitcnt lgkmcnt(0)
    buffer_load_dwordx4 v185, s[16:19], s38 offen offset:1024 nt lds
    v_permlane16_swap_b32 v208, v209
    v_mfma_f32_16x16x32_bf16 v[140:143], a[112:115], a[0:3], 0
    v_max_f32 v208, v208, v209
    v_mov_b32 v209, v208
    v_mfma_f32_16x16x32_bf16 v[140:143], a[116:119], a[4:7], v[140:143]
    s_cmp_eq_u32 s39, 49152
    s_cselect_b32 s39, 0, s39
    buffer_load_dwordx4 v186, s[16:19], s38 offen offset:2048 nt lds
    v_mfma_f32_16x16x32_bf16 v[140:143], a[120:123], a[8:11], v[140:143]
    s_sub_u32 s28, s39, s27
    v_permlane32_swap_b32 v208, v209
    v_mfma_f32_16x16x32_bf16 v[140:143], a[124:127], a[12:15], v[140:143]
    buffer_load_dwordx4 v187, s[16:19], s38 offen offset:3072 nt lds
    v_max_f32 v208, v208, v209
    v_mul_f32 v192, s31, v208
    v_fma_f32 v128, v128, s31, -v192
    v_add_u32 v163, s28, v163
    v_exp_f32 v128, v128
    s_add_u32 m0, s50, 16384
    s_nop 0
    buffer_load_dwordx4 v184, s[8:11], s26 offen nt lds
    v_fma_f32 v129, v129, s31, -v192
    v_exp_f32 v129, v129
    s_add_u32 s16, s16, 2031616
    s_addc_u32 s17, s17, 0
    s_mov_b32 s18, 16384
    s_add_u32 s29, s27, s50
    ds_read_b64_tr_b16 a[128:129], v168
    buffer_load_dwordx4 v185, s[8:11], s26 offen offset:1024 nt lds
    v_fma_f32 v130, v130, s31, -v192
    ds_read_b64_tr_b16 a[130:131], v168 offset:4096
    v_exp_f32 v130, v130
    ds_read_b64_tr_b16 a[132:133], v168 offset:8192
    buffer_load_dwordx4 v186, s[8:11], s26 offen offset:2048 nt lds
    v_fma_f32 v131, v131, s31, -v192
    ds_read_b64_tr_b16 a[134:135], v168 offset:12288
    ds_read_b64_tr_b16 a[136:137], v168 offset:8
    v_exp_f32 v131, v131
    v_cvt_pk_bf16_f32 v128, v128, v129
    buffer_load_dwordx4 v187, s[8:11], s26 offen offset:3072 nt lds
    v_fma_f32 v132, v132, s31, -v192
    v_cvt_pk_bf16_f32 v129, v130, v131
    s_waitcnt vmcnt(12)
    ds_read_b128 a[16:19], v164 offset:4096
    v_exp_f32 v132, v132
    s_add_u32 m0, s50, 65536
    s_nop 0
    ds_read_b128 a[20:23], v165 offset:4096
    buffer_load_dwordx4 v188, s[12:15], s26 offen nt lds
    v_fma_f32 v133, v133, s31, -v192
    ds_read_b128 a[24:27], v166 offset:4096
    v_exp_f32 v133, v133
    ds_read_b128 a[28:31], v167 offset:4096
    buffer_load_dwordx4 v188, s[12:15], s26 offen offset:1024 nt lds
    v_fma_f32 v134, v134, s31, -v192
    ds_read_b64_tr_b16 a[138:139], v168 offset:4104
    ds_read_b64_tr_b16 a[140:141], v168 offset:8200
    v_exp_f32 v134, v134
    ds_read_b64_tr_b16 a[142:143], v168 offset:12296
    buffer_load_dwordx4 v188, s[12:15], s26 offen offset:2048 nt lds
    v_fma_f32 v135, v135, s31, -v192
    ds_read_b64_tr_b16 a[144:145], v169
    ds_read_b64_tr_b16 a[146:147], v169 offset:4096
    v_exp_f32 v135, v135
    v_cvt_pk_bf16_f32 v130, v132, v133
    ds_read_b64_tr_b16 a[148:149], v169 offset:8192
    buffer_load_dwordx4 v188, s[12:15], s26 offen offset:3072 nt lds
    v_fma_f32 v136, v136, s31, -v192
    s_waitcnt lgkmcnt(6)
    ds_read_b64_tr_b16 a[150:151], v169 offset:12288
    ds_read_b64_tr_b16 a[152:153], v169 offset:8
    v_exp_f32 v136, v136
    v_mfma_f32_16x16x32_bf16 v[144:147], a[64:67], a[16:19], 0
    ds_read_b64_tr_b16 a[154:155], v169 offset:4104
    ds_read_b64_tr_b16 a[156:157], v169 offset:8200
    v_fma_f32 v137, v137, s31, -v192
    v_mfma_f32_16x16x32_bf16 v[144:147], a[68:71], a[20:23], v[144:147]
    ds_read_b64_tr_b16 a[158:159], v169 offset:12296
    v_exp_f32 v137, v137
    v_cvt_pk_bf16_f32 v131, v134, v135
    v_mfma_f32_16x16x32_bf16 v[144:147], a[72:75], a[24:27], v[144:147]
    ds_read_b64_tr_b16 a[160:161], v170
    ds_read_b64_tr_b16 a[162:163], v170 offset:4096
    v_fma_f32 v138, v138, s31, -v192
    v_mfma_f32_16x16x32_bf16 v[144:147], a[76:79], a[28:31], v[144:147]
    ds_read_b64_tr_b16 a[164:165], v170 offset:8192
    v_exp_f32 v138, v138
    v_mfma_f32_16x16x32_bf16 v[148:151], a[80:83], a[16:19], 0
    ds_read_b64_tr_b16 a[166:167], v170 offset:12288
    v_fma_f32 v139, v139, s31, -v192
    v_cvt_pk_bf16_f32 v136, v136, v137
    v_mfma_f32_16x16x32_bf16 v[148:151], a[84:87], a[20:23], v[148:151]
    ds_read_b64_tr_b16 a[168:169], v170 offset:8
    v_exp_f32 v139, v139
    v_mfma_f32_16x16x32_bf16 v[148:151], a[88:91], a[24:27], v[148:151]
    ds_read_b64_tr_b16 a[170:171], v170 offset:4104
    ds_read_b64_tr_b16 a[172:173], v170 offset:8200
    v_fma_f32 v140, v140, s31, -v192
    v_cvt_pk_bf16_f32 v137, v138, v139
    v_mfma_f32_16x16x32_bf16 v[148:151], a[92:95], a[28:31], v[148:151]
    ds_read_b64_tr_b16 a[174:175], v170 offset:12296
    v_exp_f32 v140, v140
    v_mfma_f32_16x16x32_bf16 v[152:155], a[96:99], a[16:19], 0
    v_fma_f32 v141, v141, s31, -v192
    v_max3_f32 v210, v144, v145, v146
    v_max_f32 v210, v210, v147
    v_mfma_f32_16x16x32_bf16 v[152:155], a[100:103], a[20:23], v[152:155]
    v_exp_f32 v141, v141
    v_mov_b32 v211, v210
    v_mfma_f32_16x16x32_bf16 v[152:155], a[104:107], a[24:27], v[152:155]
    ds_read_b64_tr_b16 a[176:177], v171
    v_fma_f32 v142, v142, s31, -v192
    v_cvt_pk_bf16_f32 v138, v140, v141
    v_mfma_f32_16x16x32_bf16 v[152:155], a[108:111], a[28:31], v[152:155]
    v_exp_f32 v142, v142
    v_permlane16_swap_b32 v210, v211
    v_mfma_f32_16x16x32_bf16 v[156:159], a[112:115], a[16:19], 0
    v_fma_f32 v143, v143, s31, -v192
    v_max_f32 v210, v210, v211
    v_mov_b32 v211, v210
    v_mfma_f32_16x16x32_bf16 v[156:159], a[116:119], a[20:23], v[156:159]
    ds_read_b64_tr_b16 a[178:179], v171 offset:4096
    ds_read_b64_tr_b16 a[180:181], v171 offset:8192
    v_exp_f32 v143, v143
    v_mfma_f32_16x16x32_bf16 v[156:159], a[120:123], a[24:27], v[156:159]
    v_permlane32_swap_b32 v210, v211
    v_cvt_pk_bf16_f32 v139, v142, v143
    v_mfma_f32_16x16x32_bf16 v[156:159], a[124:127], a[28:31], v[156:159]
    v_max_f32 v210, v210, v211
    v_mul_f32 v193, s31, v210
    v_add_u32 v160, s28, v160
    v_mfma_f32_16x16x32_bf16 v[0:3], a[128:131], v[128:131], 0
    ds_read_b64_tr_b16 a[182:183], v171 offset:12288
    ds_read_b64_tr_b16 a[184:185], v171 offset:8
    v_fma_f32 v144, v144, s31, -v193
    v_mfma_f32_16x16x32_bf16 v[0:3], a[132:135], v[136:139], v[0:3]
    s_waitcnt lgkmcnt(15)
    v_exp_f32 v144, v144
    s_add_u32 m0, s50, 32768
    s_nop 0
    v_mfma_f32_16x16x32_bf16 v[4:7], a[136:139], v[128:131], 0
    ds_read_b64_tr_b16 a[186:187], v171 offset:4104
    buffer_load_dwordx4 v184, s[8:11], s5 offen nt lds
    v_fma_f32 v145, v145, s31, -v193
    v_mfma_f32_16x16x32_bf16 v[4:7], a[140:143], v[136:139], v[4:7]
    ds_read_b64_tr_b16 a[188:189], v171 offset:8200
    v_exp_f32 v145, v145
    v_mfma_f32_16x16x32_bf16 v[8:11], a[144:147], v[128:131], 0
    buffer_load_dwordx4 v185, s[8:11], s5 offen offset:1024 nt lds
    v_fma_f32 v146, v146, s31, -v193
    v_mfma_f32_16x16x32_bf16 v[8:11], a[148:151], v[136:139], v[8:11]
    s_waitcnt lgkmcnt(15)
    ds_read_b64_tr_b16 a[190:191], v171 offset:12296
    v_exp_f32 v146, v146
    v_mfma_f32_16x16x32_bf16 v[12:15], a[152:155], v[128:131], 0
    buffer_load_dwordx4 v186, s[8:11], s5 offen offset:2048 nt lds
    v_fma_f32 v147, v147, s31, -v193
    v_mfma_f32_16x16x32_bf16 v[12:15], a[156:159], v[136:139], v[12:15]
    s_waitcnt lgkmcnt(12)
    v_exp_f32 v147, v147
    v_cvt_pk_bf16_f32 v144, v144, v145
    v_mfma_f32_16x16x32_bf16 v[16:19], a[160:163], v[128:131], 0
    buffer_load_dwordx4 v187, s[8:11], s5 offen offset:3072 nt lds
    v_fma_f32 v148, v148, s31, -v193
    v_mfma_f32_16x16x32_bf16 v[16:19], a[164:167], v[136:139], v[16:19]
    s_waitcnt lgkmcnt(8)
    s_waitcnt vmcnt(16)
    ds_read_b128 a[32:35], v164 offset:8192
    v_exp_f32 v148, v148
    s_add_u32 m0, s50, 81920
    s_nop 0
    v_mfma_f32_16x16x32_bf16 v[20:23], a[168:171], v[128:131], 0
    ds_read_b128 a[36:39], v165 offset:8192
    buffer_load_dwordx4 v188, s[12:15], s5 offen nt lds
    v_fma_f32 v149, v149, s31, -v193
    v_mfma_f32_16x16x32_bf16 v[20:23], a[172:175], v[136:139], v[20:23]
    s_waitcnt lgkmcnt(6)
    ds_read_b128 a[40:43], v166 offset:8192
    v_exp_f32 v149, v149
    v_cvt_pk_bf16_f32 v145, v146, v147
    v_mfma_f32_16x16x32_bf16 v[24:27], a[176:179], v[128:131], 0
    ds_read_b128 a[44:47], v167 offset:8192
    buffer_load_dwordx4 v188, s[12:15], s5 offen offset:1024 nt lds
    v_fma_f32 v150, v150, s31, -v193
    v_mfma_f32_16x16x32_bf16 v[24:27], a[180:183], v[136:139], v[24:27]
    s_waitcnt lgkmcnt(4)
    v_exp_f32 v150, v150
    v_cvt_pk_bf16_f32 v146, v148, v149
    v_mfma_f32_16x16x32_bf16 v[28:31], a[184:187], v[128:131], 0
    buffer_load_dwordx4 v188, s[12:15], s5 offen offset:2048 nt lds
    v_fma_f32 v151, v151, s31, -v193
    v_mfma_f32_16x16x32_bf16 v[28:31], a[188:191], v[136:139], v[28:31]
    v_exp_f32 v151, v151
    v_mfma_f32_16x16x32_bf16 a[192:195], a[208:211], v[128:131], 0
    buffer_load_dwordx4 v188, s[12:15], s5 offen offset:3072 nt lds
    v_fma_f32 v152, v152, s31, -v193
    v_mfma_f32_16x16x32_bf16 a[192:195], a[208:211], v[136:139], a[192:195]
    s_waitcnt lgkmcnt(0)
    v_exp_f32 v152, v152
    v_mfma_f32_16x16x32_bf16 v[128:131], a[64:67], a[32:35], 0
    v_fma_f32 v153, v153, s31, -v193
    v_add_u32 v161, s28, v161
    v_mfma_f32_16x16x32_bf16 v[128:131], a[68:71], a[36:39], v[128:131]
    v_exp_f32 v153, v153
    v_cvt_pk_bf16_f32 v147, v150, v151
    v_mfma_f32_16x16x32_bf16 v[128:131], a[72:75], a[40:43], v[128:131]
    v_fma_f32 v154, v154, s31, -v193
    v_cvt_pk_bf16_f32 v152, v152, v153
    v_mfma_f32_16x16x32_bf16 v[128:131], a[76:79], a[44:47], v[128:131]
    v_exp_f32 v154, v154
    v_mfma_f32_16x16x32_bf16 v[132:135], a[80:83], a[32:35], 0
    v_fma_f32 v155, v155, s31, -v193
    v_add_u32 v168, s28, v168
    v_mfma_f32_16x16x32_bf16 v[132:135], a[84:87], a[36:39], v[132:135]
    v_exp_f32 v155, v155
    v_mfma_f32_16x16x32_bf16 v[132:135], a[88:91], a[40:43], v[132:135]
    v_fma_f32 v156, v156, s31, -v193
    v_cvt_pk_bf16_f32 v153, v154, v155
    v_mfma_f32_16x16x32_bf16 v[132:135], a[92:95], a[44:47], v[132:135]
    v_exp_f32 v156, v156
    v_mfma_f32_16x16x32_bf16 v[136:139], a[96:99], a[32:35], 0
    v_fma_f32 v157, v157, s31, -v193
    v_max3_f32 v208, v128, v129, v130
    v_max_f32 v208, v208, v131
    v_mfma_f32_16x16x32_bf16 v[136:139], a[100:103], a[36:39], v[136:139]
    v_exp_f32 v157, v157
    v_mov_b32 v209, v208
    v_mfma_f32_16x16x32_bf16 v[136:139], a[104:107], a[40:43], v[136:139]
    v_fma_f32 v158, v158, s31, -v193
    v_add_u32 v171, s28, v171
    v_mfma_f32_16x16x32_bf16 v[136:139], a[108:111], a[44:47], v[136:139]
    v_exp_f32 v158, v158
    v_permlane16_swap_b32 v208, v209
    v_mfma_f32_16x16x32_bf16 v[140:143], a[112:115], a[32:35], 0
    v_fma_f32 v159, v159, s31, -v193
    v_max_f32 v208, v208, v209
    v_mov_b32 v209, v208
    v_mfma_f32_16x16x32_bf16 v[140:143], a[116:119], a[36:39], v[140:143]
    v_exp_f32 v159, v159
    v_cvt_pk_bf16_f32 v154, v156, v157
    v_mfma_f32_16x16x32_bf16 v[140:143], a[120:123], a[40:43], v[140:143]
    v_permlane32_swap_b32 v208, v209
    v_cvt_pk_bf16_f32 v155, v158, v159
    v_mfma_f32_16x16x32_bf16 v[140:143], a[124:127], a[44:47], v[140:143]
    s_mov_b32 m0, s34
    v_max_f32 v208, v208, v209
    v_mul_f32 v194, s31, v208
    v_mfma_f32_16x16x32_bf16 v[32:35], a[128:131], v[144:147], 0
    buffer_load_dwordx4 v184, s[16:19], 0 offen nt lds
    v_fma_f32 v128, v128, s31, -v194
    v_mfma_f32_16x16x32_bf16 v[32:35], a[132:135], v[152:155], v[32:35]
    s_mov_b32 m0, s34
    v_exp_f32 v128, v128
    v_add_u32 v169, s28, v169
    v_mfma_f32_16x16x32_bf16 v[36:39], a[136:139], v[144:147], 0
    buffer_load_dwordx4 v185, s[16:19], 0 offen offset:1024 nt lds
    v_fma_f32 v129, v129, s31, -v194
    v_mfma_f32_16x16x32_bf16 v[36:39], a[140:143], v[152:155], v[36:39]
    v_exp_f32 v129, v129
    v_mfma_f32_16x16x32_bf16 v[40:43], a[144:147], v[144:147], 0
    v_fma_f32 v130, v130, s31, -v194
    v_add_u32 v162, s28, v162
    v_mfma_f32_16x16x32_bf16 v[40:43], a[148:151], v[152:155], v[40:43]
    v_exp_f32 v130, v130
    v_mfma_f32_16x16x32_bf16 v[44:47], a[152:155], v[144:147], 0
    v_fma_f32 v131, v131, s31, -v194
    v_cvt_pk_bf16_f32 v128, v128, v129
    v_mfma_f32_16x16x32_bf16 v[44:47], a[156:159], v[152:155], v[44:47]
    v_exp_f32 v131, v131
    v_mfma_f32_16x16x32_bf16 v[48:51], a[160:163], v[144:147], 0
    v_fma_f32 v132, v132, s31, -v194
    v_cvt_pk_bf16_f32 v129, v130, v131
    v_mfma_f32_16x16x32_bf16 v[48:51], a[164:167], v[152:155], v[48:51]
    s_waitcnt vmcnt(18)
    ds_read_b128 a[48:51], v164 offset:12288
    v_exp_f32 v132, v132
    v_mfma_f32_16x16x32_bf16 v[52:55], a[168:171], v[144:147], 0
    ds_read_b128 a[52:55], v165 offset:12288
    v_fma_f32 v133, v133, s31, -v194
    v_mfma_f32_16x16x32_bf16 v[52:55], a[172:175], v[152:155], v[52:55]
    ds_read_b128 a[56:59], v166 offset:12288
    v_exp_f32 v133, v133
    v_mfma_f32_16x16x32_bf16 v[56:59], a[176:179], v[144:147], 0
    ds_read_b128 a[60:63], v167 offset:12288
    v_fma_f32 v134, v134, s31, -v194
    v_mfma_f32_16x16x32_bf16 v[56:59], a[180:183], v[152:155], v[56:59]
    v_exp_f32 v134, v134
    v_mfma_f32_16x16x32_bf16 v[60:63], a[184:187], v[144:147], 0
    v_fma_f32 v135, v135, s31, -v194
    v_cvt_pk_bf16_f32 v130, v132, v133
    v_add_u32 v170, s28, v170
    v_mfma_f32_16x16x32_bf16 v[60:63], a[188:191], v[152:155], v[60:63]
    v_exp_f32 v135, v135
    v_mfma_f32_16x16x32_bf16 a[196:199], a[208:211], v[144:147], 0
    s_add_u32 s27, s27, s28
    v_fma_f32 v136, v136, s31, -v194
    v_cvt_pk_bf16_f32 v131, v134, v135
    v_mfma_f32_16x16x32_bf16 a[196:199], a[208:211], v[152:155], a[196:199]
    s_waitcnt lgkmcnt(0)
    v_exp_f32 v136, v136
    v_mfma_f32_16x16x32_bf16 v[144:147], a[64:67], a[48:51], 0
    v_fma_f32 v137, v137, s31, -v194
    s_waitcnt vmcnt(10)
    s_barrier
    v_mfma_f32_16x16x32_bf16 v[144:147], a[68:71], a[52:55], v[144:147]
    v_exp_f32 v137, v137
    v_mfma_f32_16x16x32_bf16 v[144:147], a[72:75], a[56:59], v[144:147]
    s_mov_b32 m0, s29
    ds_read_b128 a[64:67], v160
    ds_read_b128 a[68:71], v161
    v_fma_f32 v138, v138, s31, -v194
    v_cvt_pk_bf16_f32 v136, v136, v137
    v_mfma_f32_16x16x32_bf16 v[144:147], a[76:79], a[60:63], v[144:147]
    buffer_load_dwordx4 v184, s[8:11], s25 offen nt lds
    v_exp_f32 v138, v138
    v_mfma_f32_16x16x32_bf16 v[148:151], a[80:83], a[48:51], 0
    buffer_load_dwordx4 v185, s[8:11], s25 offen offset:1024 nt lds
    v_fma_f32 v139, v139, s31, -v194
    v_mfma_f32_16x16x32_bf16 v[148:151], a[84:87], a[52:55], v[148:151]
    ds_read_b128 a[72:75], v162
    v_exp_f32 v139, v139
    v_mfma_f32_16x16x32_bf16 v[148:151], a[88:91], a[56:59], v[148:151]
    buffer_load_dwordx4 v186, s[8:11], s25 offen offset:2048 nt lds
    v_fma_f32 v140, v140, s31, -v194
    v_mfma_f32_16x16x32_bf16 v[148:151], a[92:95], a[60:63], v[148:151]
    ds_read_b128 a[76:79], v163
    v_exp_f32 v140, v140
    v_mfma_f32_16x16x32_bf16 v[152:155], a[96:99], a[48:51], 0
    v_fma_f32 v141, v141, s31, -v194
    v_max3_f32 v210, v144, v145, v146
    v_max_f32 v210, v210, v147
    v_mfma_f32_16x16x32_bf16 v[152:155], a[100:103], a[52:55], v[152:155]
    v_exp_f32 v141, v141
    v_mov_b32 v211, v210
    v_cvt_pk_bf16_f32 v137, v138, v139
    v_mfma_f32_16x16x32_bf16 v[152:155], a[104:107], a[56:59], v[152:155]
    buffer_load_dwordx4 v187, s[8:11], s25 offen offset:3072 nt lds
    v_fma_f32 v142, v142, s31, -v194
    v_mfma_f32_16x16x32_bf16 v[152:155], a[108:111], a[60:63], v[152:155]
    v_exp_f32 v142, v142
    v_permlane16_swap_b32 v210, v211
    v_mfma_f32_16x16x32_bf16 v[156:159], a[112:115], a[48:51], 0
    ds_read_b128 a[80:83], v160 offset:4096
    v_fma_f32 v143, v143, s31, -v194
    v_max_f32 v210, v210, v211
    v_mov_b32 v211, v210
    v_mfma_f32_16x16x32_bf16 v[156:159], a[116:119], a[52:55], v[156:159]
    ds_read_b128 a[84:87], v161 offset:4096
    v_exp_f32 v143, v143
    v_cvt_pk_bf16_f32 v138, v140, v141
    v_mfma_f32_16x16x32_bf16 v[156:159], a[120:123], a[56:59], v[156:159]
    v_permlane32_swap_b32 v210, v211
    v_cvt_pk_bf16_f32 v139, v142, v143
    v_mfma_f32_16x16x32_bf16 v[156:159], a[124:127], a[60:63], v[156:159]
    ds_read_b128 a[88:91], v162 offset:4096
    v_max_f32 v210, v210, v211
    v_fma_f32 v195, v210, s31, v253
    v_mfma_f32_16x16x32_bf16 v[64:67], a[128:131], v[128:131], 0
    ds_read_b128 a[92:95], v163 offset:4096
    ds_read_b128 a[96:99], v160 offset:8192
    v_fma_f32 v144, v144, s31, -v195
    v_mfma_f32_16x16x32_bf16 v[64:67], a[132:135], v[136:139], v[64:67]
    s_add_u32 m0, s29, 49152
    ds_read_b128 a[100:103], v161 offset:8192
    v_exp_f32 v144, v144
    v_mfma_f32_16x16x32_bf16 v[68:71], a[136:139], v[128:131], 0
    buffer_load_dwordx4 v188, s[12:15], s25 offen nt lds
    v_fma_f32 v145, v145, s31, -v195
    v_mfma_f32_16x16x32_bf16 v[68:71], a[140:143], v[136:139], v[68:71]
    buffer_load_dwordx4 v188, s[12:15], s25 offen offset:1024 nt lds
    v_exp_f32 v145, v145
    v_mfma_f32_16x16x32_bf16 v[72:75], a[144:147], v[128:131], 0
    v_fma_f32 v146, v146, s31, -v195
    v_cvt_pk_bf16_f32 v144, v144, v145
    v_mfma_f32_16x16x32_bf16 v[72:75], a[148:151], v[136:139], v[72:75]
    v_exp_f32 v146, v146
    v_mfma_f32_16x16x32_bf16 v[76:79], a[152:155], v[128:131], 0
    buffer_load_dwordx4 v188, s[12:15], s25 offen offset:2048 nt lds
    v_fma_f32 v147, v147, s31, -v195
    v_mfma_f32_16x16x32_bf16 v[76:79], a[156:159], v[136:139], v[76:79]
    v_exp_f32 v147, v147
    v_mfma_f32_16x16x32_bf16 v[80:83], a[160:163], v[128:131], 0
    buffer_load_dwordx4 v188, s[12:15], s25 offen offset:3072 nt lds
    v_fma_f32 v148, v148, s31, -v195
    v_cvt_pk_bf16_f32 v145, v146, v147
    v_mfma_f32_16x16x32_bf16 v[80:83], a[164:167], v[136:139], v[80:83]
    v_exp_f32 v148, v148
    v_mfma_f32_16x16x32_bf16 v[84:87], a[168:171], v[128:131], 0
    ds_read_b128 a[104:107], v162 offset:8192
    v_fma_f32 v149, v149, s31, -v195
    v_mfma_f32_16x16x32_bf16 v[84:87], a[172:175], v[136:139], v[84:87]
    ds_read_b128 a[108:111], v163 offset:8192
    v_exp_f32 v149, v149
    v_mfma_f32_16x16x32_bf16 v[88:91], a[176:179], v[128:131], 0
    v_fma_f32 v150, v150, s31, -v195
    v_cvt_pk_bf16_f32 v146, v148, v149
    v_mfma_f32_16x16x32_bf16 v[88:91], a[180:183], v[136:139], v[88:91]
    v_exp_f32 v150, v150
    v_mfma_f32_16x16x32_bf16 v[92:95], a[184:187], v[128:131], 0
    ds_read_b128 a[112:115], v160 offset:12288
    ds_read_b128 a[116:119], v161 offset:12288
    v_fma_f32 v151, v151, s31, -v195
    v_mfma_f32_16x16x32_bf16 v[92:95], a[188:191], v[136:139], v[92:95]
    ds_read_b128 a[120:123], v162 offset:12288
    v_exp_f32 v151, v151
    v_mfma_f32_16x16x32_bf16 a[200:203], a[208:211], v[128:131], 0
    ds_read_b128 a[124:127], v163 offset:12288
    v_fma_f32 v152, v152, s31, -v195
    v_cvt_pk_bf16_f32 v147, v150, v151
    v_mfma_f32_16x16x32_bf16 a[200:203], a[208:211], v[136:139], a[200:203]
    s_waitcnt lgkmcnt(12)
    v_exp_f32 v152, v152
    s_branch L_tile1
.p2align 6
L_top:
    v_mfma_f32_16x16x32_bf16 v[128:131], a[64:67], a[0:3], 0
    v_fma_f32 v157, v157, s31, -v195
    v_mfma_f32_16x16x32_bf16 v[128:131], a[68:71], a[4:7], v[128:131]
    s_add_u32 s4, s4, 16384
    v_exp_f32 v157, v157
    v_mfma_f32_16x16x32_bf16 v[128:131], a[72:75], a[8:11], v[128:131]
    s_and_b32 s4, s4, 0x1ffff
    v_fma_f32 v158, v158, s31, -v195
    v_cvt_pk_bf16_f32 v154, v156, v157
    v_mfma_f32_16x16x32_bf16 v[128:131], a[76:79], a[12:15], v[128:131]
    s_waitcnt lgkmcnt(11)
    v_exp_f32 v158, v158
    v_mfma_f32_16x16x32_bf16 v[132:135], a[80:83], a[0:3], 0
    v_fma_f32 v159, v159, s31, -v195
    v_mfma_f32_16x16x32_bf16 v[132:135], a[84:87], a[4:7], v[132:135]
    s_add_u32 s25, s3, s4
    v_exp_f32 v159, v159
    v_mfma_f32_16x16x32_bf16 v[132:135], a[88:91], a[8:11], v[132:135]
    v_mfma_f32_16x16x32_bf16 v[132:135], a[92:95], a[12:15], v[132:135]
    s_waitcnt lgkmcnt(4)
    v_mfma_f32_16x16x32_bf16 v[136:139], a[96:99], a[0:3], 0
    v_max3_f32 v208, v128, v129, v130
    v_max_f32 v208, v208, v131
    v_cvt_pk_bf16_f32 v155, v158, v159
    v_mfma_f32_16x16x32_bf16 v[136:139], a[100:103], a[4:7], v[136:139]
    s_add_u32 s39, s27, 16384
    v_mov_b32 v209, v208
    v_mfma_f32_16x16x32_bf16 v[136:139], a[104:107], a[8:11], v[136:139]
    v_mfma_f32_16x16x32_bf16 v[136:139], a[108:111], a[12:15], v[136:139]
    s_waitcnt lgkmcnt(0)
    v_permlane16_swap_b32 v208, v209
    v_mfma_f32_16x16x32_bf16 v[140:143], a[112:115], a[0:3], 0
    v_max_f32 v208, v208, v209
    v_mov_b32 v209, v208
    v_mfma_f32_16x16x32_bf16 v[140:143], a[116:119], a[4:7], v[140:143]
    s_cmp_eq_u32 s39, 49152
    s_cselect_b32 s39, 0, s39
    v_mfma_f32_16x16x32_bf16 v[140:143], a[120:123], a[8:11], v[140:143]
    s_sub_u32 s28, s39, s27
    v_permlane32_swap_b32 v208, v209
    v_mfma_f32_16x16x32_bf16 v[140:143], a[124:127], a[12:15], v[140:143]
    v_max_f32 v208, v208, v209
    v_mul_f32 v192, s31, v208
    v_mfma_f32_16x16x32_bf16 v[96:99], a[128:131], v[144:147], v[96:99]
    v_fma_f32 v128, v128, s31, -v192
    v_add_u32 v161, s28, v161
    v_mfma_f32_16x16x32_bf16 v[96:99], a[132:135], v[152:155], v[96:99]
    v_exp_f32 v128, v128
    v_mfma_f32_16x16x32_bf16 v[100:103], a[136:139], v[144:147], v[100:103]
    ds_read_b64_tr_b16 a[128:129], v168
    ds_read_b64_tr_b16 a[130:131], v168 offset:4096
    v_fma_f32 v129, v129, s31, -v192
    v_mfma_f32_16x16x32_bf16 v[100:103], a[140:143], v[152:155], v[100:103]
    ds_read_b64_tr_b16 a[132:133], v168 offset:8192
    v_exp_f32 v129, v129
    v_mfma_f32_16x16x32_bf16 v[104:107], a[144:147], v[144:147], v[104:107]
    s_add_u32 s29, s27, s50
    ds_read_b64_tr_b16 a[134:135], v168 offset:12288
    ds_read_b64_tr_b16 a[136:137], v168 offset:8
    v_fma_f32 v130, v130, s31, -v192
    v_mfma_f32_16x16x32_bf16 v[104:107], a[148:151], v[152:155], v[104:107]
    ds_read_b64_tr_b16 a[138:139], v168 offset:4104
    v_exp_f32 v130, v130
    v_mfma_f32_16x16x32_bf16 v[108:111], a[152:155], v[144:147], v[108:111]
    ds_read_b64_tr_b16 a[140:141], v168 offset:8200
    v_fma_f32 v131, v131, s31, -v192
    v_cvt_pk_bf16_f32 v128, v128, v129
    v_mfma_f32_16x16x32_bf16 v[108:111], a[156:159], v[152:155], v[108:111]
    ds_read_b64_tr_b16 a[142:143], v168 offset:12296
    v_exp_f32 v131, v131
    v_mfma_f32_16x16x32_bf16 v[112:115], a[160:163], v[144:147], v[112:115]
    s_cmp_lt_u32 s30, 3
    s_cselect_b32 s18, 16384, 0
    ds_read_b64_tr_b16 a[144:145], v169
    v_fma_f32 v132, v132, s31, -v192
    v_mfma_f32_16x16x32_bf16 v[112:115], a[164:167], v[152:155], v[112:115]
    ds_read_b64_tr_b16 a[146:147], v169 offset:4096
    v_exp_f32 v132, v132
    v_mfma_f32_16x16x32_bf16 v[116:119], a[168:171], v[144:147], v[116:119]
    v_fma_f32 v133, v133, s31, -v192
    v_cvt_pk_bf16_f32 v129, v130, v131
    v_mfma_f32_16x16x32_bf16 v[116:119], a[172:175], v[152:155], v[116:119]
    ds_read_b64_tr_b16 a[148:149], v169 offset:8192
    v_exp_f32 v133, v133
    v_mfma_f32_16x16x32_bf16 v[120:123], a[176:179], v[144:147], v[120:123]
    ds_read_b64_tr_b16 a[150:151], v169 offset:12288
    ds_read_b64_tr_b16 a[152:153], v169 offset:8
    v_fma_f32 v134, v134, s31, -v192
    v_mfma_f32_16x16x32_bf16 v[120:123], a[180:183], v[152:155], v[120:123]
    ds_read_b64_tr_b16 a[154:155], v169 offset:4104
    v_exp_f32 v134, v134
    v_cvt_pk_bf16_f32 v130, v132, v133
    v_mfma_f32_16x16x32_bf16 v[124:127], a[184:187], v[144:147], v[124:127]
    ds_read_b64_tr_b16 a[156:157], v169 offset:8200
    ds_read_b64_tr_b16 a[158:159], v169 offset:12296
    v_fma_f32 v135, v135, s31, -v192
    v_mfma_f32_16x16x32_bf16 v[124:127], a[188:191], v[152:155], v[124:127]
    ds_read_b64_tr_b16 a[160:161], v170
    v_exp_f32 v135, v135
    v_mfma_f32_16x16x32_bf16 a[204:207], a[208:211], v[144:147], a[204:207]
    ds_read_b64_tr_b16 a[162:163], v170 offset:4096
    ds_read_b64_tr_b16 a[164:165], v170 offset:8192
    v_fma_f32 v136, v136, s31, -v192
    v_mfma_f32_16x16x32_bf16 a[204:207], a[208:211], v[152:155], a[204:207]
    v_exp_f32 v136, v136
    v_cvt_pk_bf16_f32 v131, v134, v135
    v_accvgpr_read_b32 v204, a192
    v_accvgpr_read_b32 v205, a196
    v_accvgpr_read_b32 v206, a200
    v_rcp_f32 v196, v204
    v_rcp_f32 v198, v205
    v_rcp_f32 v200, v206
    v_pk_mul_f32 v[0:1], v[0:1], v[196:197] op_sel_hi:[1,0]
    v_pk_mul_f32 v[2:3], v[2:3], v[196:197] op_sel_hi:[1,0]
    v_pk_mul_f32 v[4:5], v[4:5], v[196:197] op_sel_hi:[1,0]
    v_pk_mul_f32 v[6:7], v[6:7], v[196:197] op_sel_hi:[1,0]
    v_pk_mul_f32 v[8:9], v[8:9], v[196:197] op_sel_hi:[1,0]
    v_pk_mul_f32 v[10:11], v[10:11], v[196:197] op_sel_hi:[1,0]
    v_pk_mul_f32 v[12:13], v[12:13], v[196:197] op_sel_hi:[1,0]
    v_pk_mul_f32 v[14:15], v[14:15], v[196:197] op_sel_hi:[1,0]
    v_cvt_pk_bf16_f32 v0, v0, v1
    v_cvt_pk_bf16_f32 v1, v2, v3
    v_cvt_pk_bf16_f32 v2, v4, v5
    v_cvt_pk_bf16_f32 v3, v6, v7
    v_cvt_pk_bf16_f32 v8, v8, v9
    v_cvt_pk_bf16_f32 v9, v10, v11
    v_cvt_pk_bf16_f32 v10, v12, v13
    v_cvt_pk_bf16_f32 v11, v14, v15
    v_pk_mul_f32 v[16:17], v[16:17], v[196:197] op_sel_hi:[1,0]
    v_pk_mul_f32 v[18:19], v[18:19], v[196:197] op_sel_hi:[1,0]
    v_pk_mul_f32 v[20:21], v[20:21], v[196:197] op_sel_hi:[1,0]
    v_pk_mul_f32 v[22:23], v[22:23], v[196:197] op_sel_hi:[1,0]
    v_pk_mul_f32 v[24:25], v[24:25], v[196:197] op_sel_hi:[1,0]
    v_pk_mul_f32 v[26:27], v[26:27], v[196:197] op_sel_hi:[1,0]
    v_pk_mul_f32 v[28:29], v[28:29], v[196:197] op_sel_hi:[1,0]
    v_pk_mul_f32 v[30:31], v[30:31], v[196:197] op_sel_hi:[1,0]
    v_cvt_pk_bf16_f32 v16, v16, v17
    v_cvt_pk_bf16_f32 v17, v18, v19
    v_cvt_pk_bf16_f32 v18, v20, v21
    v_cvt_pk_bf16_f32 v19, v22, v23
    v_cvt_pk_bf16_f32 v24, v24, v25
    v_cvt_pk_bf16_f32 v25, v26, v27
    v_cvt_pk_bf16_f32 v26, v28, v29
    v_cvt_pk_bf16_f32 v27, v30, v31
    v_accvgpr_read_b32 v207, a204
    v_pk_mul_f32 v[32:33], v[32:33], v[198:199] op_sel_hi:[1,0]
    v_pk_mul_f32 v[34:35], v[34:35], v[198:199] op_sel_hi:[1,0]
    v_pk_mul_f32 v[36:37], v[36:37], v[198:199] op_sel_hi:[1,0]
    v_pk_mul_f32 v[38:39], v[38:39], v[198:199] op_sel_hi:[1,0]
    v_pk_mul_f32 v[40:41], v[40:41], v[198:199] op_sel_hi:[1,0]
    v_pk_mul_f32 v[42:43], v[42:43], v[198:199] op_sel_hi:[1,0]
    v_pk_mul_f32 v[44:45], v[44:45], v[198:199] op_sel_hi:[1,0]
    v_pk_mul_f32 v[46:47], v[46:47], v[198:199] op_sel_hi:[1,0]
    v_cvt_pk_bf16_f32 v32, v32, v33
    v_cvt_pk_bf16_f32 v33, v34, v35
    v_cvt_pk_bf16_f32 v34, v36, v37
    v_cvt_pk_bf16_f32 v35, v38, v39
    v_cvt_pk_bf16_f32 v40, v40, v41
    v_cvt_pk_bf16_f32 v41, v42, v43
    v_cvt_pk_bf16_f32 v42, v44, v45
    v_cvt_pk_bf16_f32 v43, v46, v47
    v_pk_mul_f32 v[48:49], v[48:49], v[198:199] op_sel_hi:[1,0]
    v_pk_mul_f32 v[50:51], v[50:51], v[198:199] op_sel_hi:[1,0]
    v_pk_mul_f32 v[52:53], v[52:53], v[198:199] op_sel_hi:[1,0]
    v_pk_mul_f32 v[54:55], v[54:55], v[198:199] op_sel_hi:[1,0]
    v_pk_mul_f32 v[56:57], v[56:57], v[198:199] op_sel_hi:[1,0]
    v_pk_mul_f32 v[58:59], v[58:59], v[198:199] op_sel_hi:[1,0]
    v_pk_mul_f32 v[60:61], v[60:61], v[198:199] op_sel_hi:[1,0]
    v_pk_mul_f32 v[62:63], v[62:63], v[198:199] op_sel_hi:[1,0]
    v_cvt_pk_bf16_f32 v48, v48, v49
    v_cvt_pk_bf16_f32 v49, v50, v51
    v_cvt_pk_bf16_f32 v50, v52, v53
    v_cvt_pk_bf16_f32 v51, v54, v55
    v_cvt_pk_bf16_f32 v56, v56, v57
    v_cvt_pk_bf16_f32 v57, v58, v59
    v_cvt_pk_bf16_f32 v58, v60, v61
    v_cvt_pk_bf16_f32 v59, v62, v63
    v_rcp_f32 v202, v207
    v_pk_mul_f32 v[64:65], v[64:65], v[200:201] op_sel_hi:[1,0]
    v_pk_mul_f32 v[66:67], v[66:67], v[200:201] op_sel_hi:[1,0]
    v_pk_mul_f32 v[68:69], v[68:69], v[200:201] op_sel_hi:[1,0]
    v_pk_mul_f32 v[70:71], v[70:71], v[200:201] op_sel_hi:[1,0]
    v_pk_mul_f32 v[72:73], v[72:73], v[200:201] op_sel_hi:[1,0]
    v_pk_mul_f32 v[74:75], v[74:75], v[200:201] op_sel_hi:[1,0]
    v_pk_mul_f32 v[76:77], v[76:77], v[200:201] op_sel_hi:[1,0]
    v_pk_mul_f32 v[78:79], v[78:79], v[200:201] op_sel_hi:[1,0]
    v_cvt_pk_bf16_f32 v64, v64, v65
    v_cvt_pk_bf16_f32 v65, v66, v67
    v_cvt_pk_bf16_f32 v66, v68, v69
    v_cvt_pk_bf16_f32 v67, v70, v71
    v_cvt_pk_bf16_f32 v72, v72, v73
    v_cvt_pk_bf16_f32 v73, v74, v75
    v_cvt_pk_bf16_f32 v74, v76, v77
    v_cvt_pk_bf16_f32 v75, v78, v79
    v_pk_mul_f32 v[80:81], v[80:81], v[200:201] op_sel_hi:[1,0]
    v_pk_mul_f32 v[82:83], v[82:83], v[200:201] op_sel_hi:[1,0]
    v_pk_mul_f32 v[84:85], v[84:85], v[200:201] op_sel_hi:[1,0]
    v_pk_mul_f32 v[86:87], v[86:87], v[200:201] op_sel_hi:[1,0]
    v_pk_mul_f32 v[88:89], v[88:89], v[200:201] op_sel_hi:[1,0]
    v_pk_mul_f32 v[90:91], v[90:91], v[200:201] op_sel_hi:[1,0]
    v_pk_mul_f32 v[92:93], v[92:93], v[200:201] op_sel_hi:[1,0]
    v_pk_mul_f32 v[94:95], v[94:95], v[200:201] op_sel_hi:[1,0]
    v_cvt_pk_bf16_f32 v80, v80, v81
    v_cvt_pk_bf16_f32 v81, v82, v83
    v_cvt_pk_bf16_f32 v82, v84, v85
    v_cvt_pk_bf16_f32 v83, v86, v87
    v_cvt_pk_bf16_f32 v88, v88, v89
    v_cvt_pk_bf16_f32 v89, v90, v91
    v_cvt_pk_bf16_f32 v90, v92, v93
    v_cvt_pk_bf16_f32 v91, v94, v95
    v_maximum3_f32 v212, v204, v205, v206
    v_maximum3_f32 v212, v212, v207, v207
    v_cmp_ngt_f32 s[40:41], s32, v212
    v_pk_mul_f32 v[96:97], v[96:97], v[202:203] op_sel_hi:[1,0]
    v_pk_mul_f32 v[98:99], v[98:99], v[202:203] op_sel_hi:[1,0]
    v_pk_mul_f32 v[100:101], v[100:101], v[202:203] op_sel_hi:[1,0]
    v_pk_mul_f32 v[102:103], v[102:103], v[202:203] op_sel_hi:[1,0]
    v_pk_mul_f32 v[104:105], v[104:105], v[202:203] op_sel_hi:[1,0]
    v_pk_mul_f32 v[106:107], v[106:107], v[202:203] op_sel_hi:[1,0]
    v_pk_mul_f32 v[108:109], v[108:109], v[202:203] op_sel_hi:[1,0]
    v_pk_mul_f32 v[110:111], v[110:111], v[202:203] op_sel_hi:[1,0]
    v_cvt_pk_bf16_f32 v96, v96, v97
    v_cvt_pk_bf16_f32 v97, v98, v99
    v_cvt_pk_bf16_f32 v98, v100, v101
    v_cvt_pk_bf16_f32 v99, v102, v103
    v_cvt_pk_bf16_f32 v104, v104, v105
    v_cvt_pk_bf16_f32 v105, v106, v107
    v_cvt_pk_bf16_f32 v106, v108, v109
    v_cvt_pk_bf16_f32 v107, v110, v111
    v_pk_mul_f32 v[112:113], v[112:113], v[202:203] op_sel_hi:[1,0]
    v_pk_mul_f32 v[114:115], v[114:115], v[202:203] op_sel_hi:[1,0]
    v_pk_mul_f32 v[116:117], v[116:117], v[202:203] op_sel_hi:[1,0]
    v_pk_mul_f32 v[118:119], v[118:119], v[202:203] op_sel_hi:[1,0]
    v_pk_mul_f32 v[120:121], v[120:121], v[202:203] op_sel_hi:[1,0]
    v_pk_mul_f32 v[122:123], v[122:123], v[202:203] op_sel_hi:[1,0]
    v_pk_mul_f32 v[124:125], v[124:125], v[202:203] op_sel_hi:[1,0]
    v_pk_mul_f32 v[126:127], v[126:127], v[202:203] op_sel_hi:[1,0]
    v_cvt_pk_bf16_f32 v112, v112, v113
    v_cvt_pk_bf16_f32 v113, v114, v115
    v_cvt_pk_bf16_f32 v114, v116, v117
    v_cvt_pk_bf16_f32 v115, v118, v119
    v_cvt_pk_bf16_f32 v120, v120, v121
    v_cvt_pk_bf16_f32 v121, v122, v123
    v_cvt_pk_bf16_f32 v122, v124, v125
    v_cvt_pk_bf16_f32 v123, v126, v127
    v_mfma_f32_16x16x32_bf16 v[144:147], a[64:67], a[16:19], 0
    ds_write_b128 v164, v[0:3]
    v_fma_f32 v137, v137, s31, -v192
    v_mfma_f32_16x16x32_bf16 v[144:147], a[68:71], a[20:23], v[144:147]
    ds_read_b64_tr_b16 a[166:167], v170 offset:12288
    v_exp_f32 v137, v137
    v_mfma_f32_16x16x32_bf16 v[144:147], a[72:75], a[24:27], v[144:147]
    s_cmp_lg_u64 s[40:41], 0
    s_cselect_b32 s40, s51, 0
    v_fma_f32 v138, v138, s31, -v192
    v_mfma_f32_16x16x32_bf16 v[144:147], a[76:79], a[28:31], v[144:147]
    v_exp_f32 v138, v138
    v_cvt_pk_bf16_f32 v136, v136, v137
    v_mfma_f32_16x16x32_bf16 v[148:151], a[80:83], a[16:19], 0
    s_or_b32 s33, s33, s40
    ds_read_b64_tr_b16 a[168:169], v170 offset:8
    v_fma_f32 v139, v139, s31, -v192
    v_add_u32 v160, s28, v160
    v_mfma_f32_16x16x32_bf16 v[148:151], a[84:87], a[20:23], v[148:151]
    ds_read_b64_tr_b16 a[170:171], v170 offset:4104
    v_exp_f32 v139, v139
    v_mfma_f32_16x16x32_bf16 v[148:151], a[88:91], a[24:27], v[148:151]
    s_lshl_b32 s51, s51, 1
    ds_write_b128 v165, v[8:11]
    v_fma_f32 v140, v140, s31, -v192
    v_mfma_f32_16x16x32_bf16 v[148:151], a[92:95], a[28:31], v[148:151]
    ds_read_b64_tr_b16 a[172:173], v170 offset:8200
    v_exp_f32 v140, v140
    v_mfma_f32_16x16x32_bf16 v[152:155], a[96:99], a[16:19], 0
    s_add_u32 s20, s20, 2031616
    s_addc_u32 s21, s21, 0
    v_fma_f32 v141, v141, s31, -v192
    v_max3_f32 v210, v144, v145, v146
    v_max_f32 v210, v210, v147
    v_mfma_f32_16x16x32_bf16 v[152:155], a[100:103], a[20:23], v[152:155]
    v_exp_f32 v141, v141
    v_mov_b32 v211, v210
    v_cvt_pk_bf16_f32 v137, v138, v139
    v_mfma_f32_16x16x32_bf16 v[152:155], a[104:107], a[24:27], v[152:155]
    s_mov_b32 s22, 16384
    ds_write_b128 v166, v[16:19]
    v_fma_f32 v142, v142, s31, -v192
    v_mfma_f32_16x16x32_bf16 v[152:155], a[108:111], a[28:31], v[152:155]
    v_exp_f32 v142, v142
    v_permlane16_swap_b32 v210, v211
    v_mfma_f32_16x16x32_bf16 v[156:159], a[112:115], a[16:19], 0
    s_add_u32 s16, s16, 2031616
    s_addc_u32 s17, s17, 0
    v_fma_f32 v143, v143, s31, -v192
    v_max_f32 v210, v210, v211
    v_mov_b32 v211, v210
    v_mfma_f32_16x16x32_bf16 v[156:159], a[116:119], a[20:23], v[156:159]
    ds_read_b64_tr_b16 a[174:175], v170 offset:12296
    v_exp_f32 v143, v143
    v_cvt_pk_bf16_f32 v138, v140, v141
    v_mfma_f32_16x16x32_bf16 v[156:159], a[120:123], a[24:27], v[156:159]
    v_permlane32_swap_b32 v210, v211
    v_cvt_pk_bf16_f32 v139, v142, v143
    v_mfma_f32_16x16x32_bf16 v[156:159], a[124:127], a[28:31], v[156:159]
    s_waitcnt lgkmcnt(15)
    v_max_f32 v210, v210, v211
    v_mul_f32 v193, s31, v210
    v_mfma_f32_16x16x32_bf16 v[0:3], a[128:131], v[128:131], 0
    ds_read_b64_tr_b16 a[176:177], v171
    ds_read_b64_tr_b16 a[178:179], v171 offset:4096
    v_fma_f32 v144, v144, s31, -v193
    v_mfma_f32_16x16x32_bf16 v[0:3], a[132:135], v[136:139], v[0:3]
    v_exp_f32 v144, v144
    v_mfma_f32_16x16x32_bf16 v[4:7], a[136:139], v[128:131], 0
    ds_write_b128 v167, v[24:27]
    v_fma_f32 v145, v145, s31, -v193
    v_mfma_f32_16x16x32_bf16 v[4:7], a[140:143], v[136:139], v[4:7]
    v_exp_f32 v145, v145
    v_mfma_f32_16x16x32_bf16 v[8:11], a[144:147], v[128:131], 0
    ds_write_b128 v164, v[32:35] offset:4096
    v_fma_f32 v146, v146, s31, -v193
    v_mfma_f32_16x16x32_bf16 v[8:11], a[148:151], v[136:139], v[8:11]
    s_waitcnt lgkmcnt(15)
    ds_read_b64_tr_b16 a[180:181], v171 offset:8192
    v_exp_f32 v146, v146
    v_mfma_f32_16x16x32_bf16 v[12:15], a[152:155], v[128:131], 0
    ds_read_b64_tr_b16 a[182:183], v171 offset:12288
    ds_read_b64_tr_b16 a[184:185], v171 offset:8
    v_fma_f32 v147, v147, s31, -v193
    v_mfma_f32_16x16x32_bf16 v[12:15], a[156:159], v[136:139], v[12:15]
    s_waitcnt lgkmcnt(13)
    ds_read_b64_tr_b16 a[186:187], v171 offset:4104
    v_exp_f32 v147, v147
    v_cvt_pk_bf16_f32 v144, v144, v145
    v_mfma_f32_16x16x32_bf16 v[16:19], a[160:163], v[128:131], 0
    ds_read_b64_tr_b16 a[188:189], v171 offset:8200
    ds_read_b64_tr_b16 a[190:191], v171 offset:12296
    v_fma_f32 v148, v148, s31, -v193
    v_mfma_f32_16x16x32_bf16 v[16:19], a[164:167], v[136:139], v[16:19]
    s_waitcnt lgkmcnt(10)
    v_exp_f32 v148, v148
    v_mfma_f32_16x16x32_bf16 v[20:23], a[168:171], v[128:131], 0
    v_fma_f32 v149, v149, s31, -v193
    v_cvt_pk_bf16_f32 v145, v146, v147
    v_mfma_f32_16x16x32_bf16 v[20:23], a[172:175], v[136:139], v[20:23]
    s_waitcnt lgkmcnt(4)
    v_exp_f32 v149, v149
    v_mfma_f32_16x16x32_bf16 v[24:27], a[176:179], v[128:131], 0
    v_fma_f32 v150, v150, s31, -v193
    v_cvt_pk_bf16_f32 v146, v148, v149
    v_mfma_f32_16x16x32_bf16 v[24:27], a[180:183], v[136:139], v[24:27]
    s_waitcnt lgkmcnt(0)
    v_exp_f32 v150, v150
    v_add_u32 v162, s28, v162
    v_mfma_f32_16x16x32_bf16 v[28:31], a[184:187], v[128:131], 0
    ds_write_b128 v165, v[40:43] offset:4096
    v_fma_f32 v151, v151, s31, -v193
    v_mfma_f32_16x16x32_bf16 v[28:31], a[188:191], v[136:139], v[28:31]
    ds_read_b128 a[212:215], v190
    v_exp_f32 v151, v151
    v_mfma_f32_16x16x32_bf16 a[192:195], a[208:211], v[128:131], 0
    ds_write_b128 v166, v[48:51] offset:4096
    v_fma_f32 v152, v152, s31, -v193
    v_mfma_f32_16x16x32_bf16 a[192:195], a[208:211], v[136:139], a[192:195]
    ds_read_b128 a[216:219], v190 offset:1024
    v_exp_f32 v152, v152
    v_mfma_f32_16x16x32_bf16 v[128:131], a[64:67], a[32:35], 0
    v_fma_f32 v153, v153, s31, -v193
    v_cvt_pk_bf16_f32 v147, v150, v151
    v_mfma_f32_16x16x32_bf16 v[128:131], a[68:71], a[36:39], v[128:131]
    v_exp_f32 v153, v153
    v_mfma_f32_16x16x32_bf16 v[128:131], a[72:75], a[40:43], v[128:131]
    ds_read_b128 a[220:223], v190 offset:2048
    v_fma_f32 v154, v154, s31, -v193
    v_cvt_pk_bf16_f32 v152, v152, v153
    v_mfma_f32_16x16x32_bf16 v[128:131], a[76:79], a[44:47], v[128:131]
    v_exp_f32 v154, v154
    v_mfma_f32_16x16x32_bf16 v[132:135], a[80:83], a[32:35], 0
    s_waitcnt lgkmcnt(3)
    buffer_store_dwordx4 a[212:215], v184, s[20:23], 0 offen sc1 nt
    v_fma_f32 v155, v155, s31, -v193
    v_mfma_f32_16x16x32_bf16 v[132:135], a[84:87], a[36:39], v[132:135]
    v_exp_f32 v155, v155
    v_mfma_f32_16x16x32_bf16 v[132:135], a[88:91], a[40:43], v[132:135]
    ds_write_b128 v164, v[64:67] offset:8192
    v_fma_f32 v156, v156, s31, -v193
    v_mfma_f32_16x16x32_bf16 v[132:135], a[92:95], a[44:47], v[132:135]
    v_exp_f32 v156, v156
    v_cvt_pk_bf16_f32 v153, v154, v155
    v_mfma_f32_16x16x32_bf16 v[136:139], a[96:99], a[32:35], 0
    v_fma_f32 v157, v157, s31, -v193
    v_max3_f32 v208, v128, v129, v130
    v_max_f32 v208, v208, v131
    v_mfma_f32_16x16x32_bf16 v[136:139], a[100:103], a[36:39], v[136:139]
    s_mov_b32 m0, s34
    v_exp_f32 v157, v157
    v_mov_b32 v209, v208
    v_mfma_f32_16x16x32_bf16 v[136:139], a[104:107], a[40:43], v[136:139]
    buffer_load_dwordx4 v184, s[16:19], 0 offen nt lds
    v_fma_f32 v158, v158, s31, -v193
    v_mfma_f32_16x16x32_bf16 v[136:139], a[108:111], a[44:47], v[136:139]
    v_exp_f32 v158, v158
    v_permlane16_swap_b32 v208, v209
    v_mfma_f32_16x16x32_bf16 v[140:143], a[112:115], a[32:35], 0
    v_fma_f32 v159, v159, s31, -v193
    v_max_f32 v208, v208, v209
    v_mov_b32 v209, v208
    v_mfma_f32_16x16x32_bf16 v[140:143], a[116:119], a[36:39], v[140:143]
    v_exp_f32 v159, v159
    v_cvt_pk_bf16_f32 v154, v156, v157
    v_mfma_f32_16x16x32_bf16 v[140:143], a[120:123], a[40:43], v[140:143]
    v_permlane32_swap_b32 v208, v209
    v_cvt_pk_bf16_f32 v155, v158, v159
    v_mfma_f32_16x16x32_bf16 v[140:143], a[124:127], a[44:47], v[140:143]
    ds_read_b128 a[224:227], v190 offset:3072
    v_max_f32 v208, v208, v209
    v_mul_f32 v194, s31, v208
    v_mfma_f32_16x16x32_bf16 v[32:35], a[128:131], v[144:147], 0
    ds_write_b128 v165, v[72:75] offset:8192
    v_fma_f32 v128, v128, s31, -v194
    v_mfma_f32_16x16x32_bf16 v[32:35], a[132:135], v[152:155], v[32:35]
    v_exp_f32 v128, v128
    v_mfma_f32_16x16x32_bf16 v[36:39], a[136:139], v[144:147], 0
    ds_write_b128 v166, v[80:83] offset:8192
    v_fma_f32 v129, v129, s31, -v194
    v_mfma_f32_16x16x32_bf16 v[36:39], a[140:143], v[152:155], v[36:39]
    v_exp_f32 v129, v129
    v_mfma_f32_16x16x32_bf16 v[40:43], a[144:147], v[144:147], 0
    ds_write_b128 v164, v[96:99] offset:12288
    v_fma_f32 v130, v130, s31, -v194
    v_mfma_f32_16x16x32_bf16 v[40:43], a[148:151], v[152:155], v[40:43]
    v_exp_f32 v130, v130
    v_add_u32 v163, s28, v163
    v_mfma_f32_16x16x32_bf16 v[44:47], a[152:155], v[144:147], 0
    ds_write_b128 v167, v[56:59] offset:4096
    v_fma_f32 v131, v131, s31, -v194
    v_mfma_f32_16x16x32_bf16 v[44:47], a[156:159], v[152:155], v[44:47]
    s_mov_b32 m0, s34
    v_exp_f32 v131, v131
    v_cvt_pk_bf16_f32 v128, v128, v129
    v_mfma_f32_16x16x32_bf16 v[48:51], a[160:163], v[144:147], 0
    s_waitcnt lgkmcnt(7)
    buffer_load_dwordx4 v185, s[16:19], 0 offen offset:1024 nt lds
    v_fma_f32 v132, v132, s31, -v194
    v_mfma_f32_16x16x32_bf16 v[48:51], a[164:167], v[152:155], v[48:51]
    v_exp_f32 v132, v132
    v_mfma_f32_16x16x32_bf16 v[52:55], a[168:171], v[144:147], 0
    buffer_store_dwordx4 a[216:219], v185, s[20:23], 0 offen offset:1024 sc1 nt
    v_fma_f32 v133, v133, s31, -v194
    v_mfma_f32_16x16x32_bf16 v[52:55], a[172:175], v[152:155], v[52:55]
    v_exp_f32 v133, v133
    v_cvt_pk_bf16_f32 v129, v130, v131
    v_mfma_f32_16x16x32_bf16 v[56:59], a[176:179], v[144:147], 0
    v_fma_f32 v134, v134, s31, -v194
    v_cvt_pk_bf16_f32 v130, v132, v133
    v_mfma_f32_16x16x32_bf16 v[56:59], a[180:183], v[152:155], v[56:59]
    v_exp_f32 v134, v134
    v_mfma_f32_16x16x32_bf16 v[60:63], a[184:187], v[144:147], 0
    ds_write_b128 v165, v[104:107] offset:12288
    v_fma_f32 v135, v135, s31, -v194
    v_mfma_f32_16x16x32_bf16 v[60:63], a[188:191], v[152:155], v[60:63]
    v_exp_f32 v135, v135
    v_mfma_f32_16x16x32_bf16 a[196:199], a[208:211], v[144:147], 0
    s_add_u32 s27, s27, s28
    ds_write_b128 v167, v[88:91] offset:8192
    v_fma_f32 v136, v136, s31, -v194
    v_mfma_f32_16x16x32_bf16 a[196:199], a[208:211], v[152:155], a[196:199]
    v_exp_f32 v136, v136
    v_cvt_pk_bf16_f32 v131, v134, v135
    v_mfma_f32_16x16x32_bf16 v[144:147], a[64:67], a[48:51], 0
    v_fma_f32 v137, v137, s31, -v194
    s_waitcnt vmcnt(15)
    s_barrier
    v_mfma_f32_16x16x32_bf16 v[144:147], a[68:71], a[52:55], v[144:147]
    ds_read_b128 a[64:67], v160
    v_exp_f32 v137, v137
    v_mfma_f32_16x16x32_bf16 v[144:147], a[72:75], a[56:59], v[144:147]
    s_mov_b32 m0, s29
    ds_write_b128 v166, v[112:115] offset:12288
    v_fma_f32 v138, v138, s31, -v194
    v_mfma_f32_16x16x32_bf16 v[144:147], a[76:79], a[60:63], v[144:147]
    buffer_load_dwordx4 v184, s[8:11], s25 offen nt lds
    v_exp_f32 v138, v138
    v_mfma_f32_16x16x32_bf16 v[148:151], a[80:83], a[48:51], 0
    buffer_load_dwordx4 v185, s[8:11], s25 offen offset:1024 nt lds
    v_fma_f32 v139, v139, s31, -v194
    v_mfma_f32_16x16x32_bf16 v[148:151], a[84:87], a[52:55], v[148:151]
    v_exp_f32 v139, v139
    v_cvt_pk_bf16_f32 v136, v136, v137
    v_mfma_f32_16x16x32_bf16 v[148:151], a[88:91], a[56:59], v[148:151]
    ds_read_b128 a[68:71], v161
    v_fma_f32 v140, v140, s31, -v194
    v_add_u32 v170, s28, v170
    v_mfma_f32_16x16x32_bf16 v[148:151], a[92:95], a[60:63], v[148:151]
    v_exp_f32 v140, v140
    v_cvt_pk_bf16_f32 v137, v138, v139
    v_mfma_f32_16x16x32_bf16 v[152:155], a[96:99], a[48:51], 0
    v_fma_f32 v141, v141, s31, -v194
    v_max3_f32 v210, v144, v145, v146
    v_max_f32 v210, v210, v147
    v_mfma_f32_16x16x32_bf16 v[152:155], a[100:103], a[52:55], v[152:155]
    ds_read_b128 a[72:75], v162
    v_exp_f32 v141, v141
    v_mov_b32 v211, v210
    v_mfma_f32_16x16x32_bf16 v[152:155], a[104:107], a[56:59], v[152:155]
    buffer_load_dwordx4 v186, s[8:11], s25 offen offset:2048 nt lds
    v_fma_f32 v142, v142, s31, -v194
    v_mfma_f32_16x16x32_bf16 v[152:155], a[108:111], a[60:63], v[152:155]
    v_exp_f32 v142, v142
    v_permlane16_swap_b32 v210, v211
    v_mfma_f32_16x16x32_bf16 v[156:159], a[112:115], a[48:51], 0
    v_fma_f32 v143, v143, s31, -v194
    v_max_f32 v210, v210, v211
    v_mov_b32 v211, v210
    v_mfma_f32_16x16x32_bf16 v[156:159], a[116:119], a[52:55], v[156:159]
    v_exp_f32 v143, v143
    v_cvt_pk_bf16_f32 v138, v140, v141
    v_mfma_f32_16x16x32_bf16 v[156:159], a[120:123], a[56:59], v[156:159]
    v_permlane32_swap_b32 v210, v211
    v_cvt_pk_bf16_f32 v139, v142, v143
    v_mfma_f32_16x16x32_bf16 v[156:159], a[124:127], a[60:63], v[156:159]
    ds_read_b128 a[76:79], v163
    v_max_f32 v210, v210, v211
    v_fma_f32 v195, v210, s31, v253
    v_mfma_f32_16x16x32_bf16 v[64:67], a[128:131], v[128:131], 0
    buffer_load_dwordx4 v187, s[8:11], s25 offen offset:3072 nt lds
    v_fma_f32 v144, v144, s31, -v195
    v_mfma_f32_16x16x32_bf16 v[64:67], a[132:135], v[136:139], v[64:67]
    s_add_u32 m0, s29, 49152
    v_exp_f32 v144, v144
    v_add_u32 v168, s28, v168
    v_mfma_f32_16x16x32_bf16 v[68:71], a[136:139], v[128:131], 0
    buffer_load_dwordx4 v188, s[12:15], s25 offen nt lds
    v_fma_f32 v145, v145, s31, -v195
    v_mfma_f32_16x16x32_bf16 v[68:71], a[140:143], v[136:139], v[68:71]
    ds_read_b128 a[80:83], v160 offset:4096
    v_exp_f32 v145, v145
    v_mfma_f32_16x16x32_bf16 v[72:75], a[144:147], v[128:131], 0
    buffer_load_dwordx4 v188, s[12:15], s25 offen offset:1024 nt lds
    v_fma_f32 v146, v146, s31, -v195
    v_cvt_pk_bf16_f32 v144, v144, v145
    v_mfma_f32_16x16x32_bf16 v[72:75], a[148:151], v[136:139], v[72:75]
    buffer_load_dwordx4 v188, s[12:15], s25 offen offset:2048 nt lds
    v_exp_f32 v146, v146
    v_mfma_f32_16x16x32_bf16 v[76:79], a[152:155], v[128:131], 0
    buffer_load_dwordx4 v188, s[12:15], s25 offen offset:3072 nt lds
    v_fma_f32 v147, v147, s31, -v195
    v_mfma_f32_16x16x32_bf16 v[76:79], a[156:159], v[136:139], v[76:79]
    ds_read_b128 a[84:87], v161 offset:4096
    v_exp_f32 v147, v147
    v_mfma_f32_16x16x32_bf16 v[80:83], a[160:163], v[128:131], 0
    ds_read_b128 a[88:91], v162 offset:4096
    v_fma_f32 v148, v148, s31, -v195
    v_cvt_pk_bf16_f32 v145, v146, v147
    v_mfma_f32_16x16x32_bf16 v[80:83], a[164:167], v[136:139], v[80:83]
    ds_read_b128 a[92:95], v163 offset:4096
    v_exp_f32 v148, v148
    v_mfma_f32_16x16x32_bf16 v[84:87], a[168:171], v[128:131], 0
    ds_read_b128 a[96:99], v160 offset:8192
    ds_read_b128 a[100:103], v161 offset:8192
    v_fma_f32 v149, v149, s31, -v195
    v_mfma_f32_16x16x32_bf16 v[84:87], a[172:175], v[136:139], v[84:87]
    v_exp_f32 v149, v149
    v_mfma_f32_16x16x32_bf16 v[88:91], a[176:179], v[128:131], 0
    v_fma_f32 v150, v150, s31, -v195
    v_cvt_pk_bf16_f32 v146, v148, v149
    v_add_u32 v171, s28, v171
    v_mfma_f32_16x16x32_bf16 v[88:91], a[180:183], v[136:139], v[88:91]
    ds_read_b128 a[104:107], v162 offset:8192
    v_exp_f32 v150, v150
    v_mfma_f32_16x16x32_bf16 v[92:95], a[184:187], v[128:131], 0
    ds_read_b128 a[108:111], v163 offset:8192
    ds_read_b128 a[112:115], v160 offset:12288
    v_fma_f32 v151, v151, s31, -v195
    v_mfma_f32_16x16x32_bf16 v[92:95], a[188:191], v[136:139], v[92:95]
    ds_read_b128 a[116:119], v161 offset:12288
    v_exp_f32 v151, v151
    v_mfma_f32_16x16x32_bf16 a[200:203], a[208:211], v[128:131], 0
    ds_read_b128 a[120:123], v162 offset:12288
    v_fma_f32 v152, v152, s31, -v195
    v_cvt_pk_bf16_f32 v147, v150, v151
    v_add_u32 v169, s28, v169
    v_mfma_f32_16x16x32_bf16 a[200:203], a[208:211], v[136:139], a[200:203]
    s_waitcnt lgkmcnt(11)
    ds_read_b128 a[124:127], v163 offset:12288
    v_exp_f32 v152, v152
L_tile1:
    v_mfma_f32_16x16x32_bf16 v[128:131], a[64:67], a[0:3], 0
    v_fma_f32 v153, v153, s31, -v195
    v_mfma_f32_16x16x32_bf16 v[128:131], a[68:71], a[4:7], v[128:131]
    s_add_u32 s4, s4, 16384
    v_exp_f32 v153, v153
    v_mfma_f32_16x16x32_bf16 v[128:131], a[72:75], a[8:11], v[128:131]
    s_and_b32 s4, s4, 0x1ffff
    v_fma_f32 v154, v154, s31, -v195
    v_cvt_pk_bf16_f32 v152, v152, v153
    v_mfma_f32_16x16x32_bf16 v[128:131], a[76:79], a[12:15], v[128:131]
    s_waitcnt lgkmcnt(8)
    v_exp_f32 v154, v154
    v_mfma_f32_16x16x32_bf16 v[132:135], a[80:83], a[0:3], 0
    ds_write_b128 v167, v[120:123] offset:12288
    v_fma_f32 v155, v155, s31, -v195
    v_mfma_f32_16x16x32_bf16 v[132:135], a[84:87], a[4:7], v[132:135]
    s_add_u32 s25, s3, s4
    v_exp_f32 v155, v155
    v_mfma_f32_16x16x32_bf16 v[132:135], a[88:91], a[8:11], v[132:135]
    v_fma_f32 v156, v156, s31, -v195
    v_cvt_pk_bf16_f32 v153, v154, v155
    v_mfma_f32_16x16x32_bf16 v[132:135], a[92:95], a[12:15], v[132:135]
    s_waitcnt lgkmcnt(5)
    v_exp_f32 v156, v156
    v_mfma_f32_16x16x32_bf16 v[136:139], a[96:99], a[0:3], 0
    v_fma_f32 v157, v157, s31, -v195
    v_fma_f32 v128, v128, s31, -v192
    v_mfma_f32_16x16x32_bf16 v[136:139], a[100:103], a[4:7], v[136:139]
    s_add_u32 s39, s27, 16384
    v_exp_f32 v157, v157
    v_exp_f32 v128, v128
    v_mfma_f32_16x16x32_bf16 v[136:139], a[104:107], a[8:11], v[136:139]
    v_fma_f32 v158, v158, s31, -v195
    v_fma_f32 v129, v129, s31, -v192
    v_cvt_pk_bf16_f32 v154, v156, v157
    v_mfma_f32_16x16x32_bf16 v[136:139], a[108:111], a[12:15], v[136:139]
    s_waitcnt lgkmcnt(1)
    v_exp_f32 v158, v158
    v_exp_f32 v129, v129
    v_mfma_f32_16x16x32_bf16 v[140:143], a[112:115], a[0:3], 0
    v_fma_f32 v159, v159, s31, -v195
    v_fma_f32 v130, v130, s31, -v192
    v_mfma_f32_16x16x32_bf16 v[140:143], a[116:119], a[4:7], v[140:143]
    s_cmp_eq_u32 s39, 49152
    s_cselect_b32 s39, 0, s39
    v_exp_f32 v159, v159
    v_exp_f32 v130, v130
    v_mfma_f32_16x16x32_bf16 v[140:143], a[120:123], a[8:11], v[140:143]
    s_sub_u32 s28, s39, s27
    v_fma_f32 v131, v131, s31, -v192
    v_cvt_pk_bf16_f32 v155, v158, v159
    v_mfma_f32_16x16x32_bf16 v[140:143], a[124:127], a[12:15], v[140:143]
    v_exp_f32 v131, v131
    v_cvt_pk_bf16_f32 v128, v128, v129
    v_mfma_f32_16x16x32_bf16 v[96:99], a[128:131], v[144:147], 0
    v_fma_f32 v132, v132, s31, -v192
    v_cvt_pk_bf16_f32 v129, v130, v131
    v_mfma_f32_16x16x32_bf16 v[96:99], a[132:135], v[152:155], v[96:99]
    v_exp_f32 v132, v132
    v_mfma_f32_16x16x32_bf16 v[100:103], a[136:139], v[144:147], 0
    ds_read_b64_tr_b16 a[128:129], v168
    ds_read_b64_tr_b16 a[130:131], v168 offset:4096
    v_fma_f32 v133, v133, s31, -v192
    v_mfma_f32_16x16x32_bf16 v[100:103], a[140:143], v[152:155], v[100:103]
    v_exp_f32 v133, v133
    v_mfma_f32_16x16x32_bf16 v[104:107], a[144:147], v[144:147], 0
    s_add_u32 s29, s27, s50
    ds_read_b64_tr_b16 a[132:133], v168 offset:8192
    v_fma_f32 v134, v134, s31, -v192
    v_cvt_pk_bf16_f32 v130, v132, v133
    v_mfma_f32_16x16x32_bf16 v[104:107], a[148:151], v[152:155], v[104:107]
    ds_read_b64_tr_b16 a[134:135], v168 offset:12288
    v_exp_f32 v134, v134
    v_mfma_f32_16x16x32_bf16 v[108:111], a[152:155], v[144:147], 0
    ds_read_b64_tr_b16 a[136:137], v168 offset:8
    ds_read_b64_tr_b16 a[138:139], v168 offset:4104
    ds_read_b64_tr_b16 a[140:141], v168 offset:8200
    v_fma_f32 v135, v135, s31, -v192
    v_mfma_f32_16x16x32_bf16 v[108:111], a[156:159], v[152:155], v[108:111]
    ds_read_b64_tr_b16 a[142:143], v168 offset:12296
    v_exp_f32 v135, v135
    v_mfma_f32_16x16x32_bf16 v[112:115], a[160:163], v[144:147], 0
    ds_read_b64_tr_b16 a[144:145], v169
    ds_read_b64_tr_b16 a[146:147], v169 offset:4096
    v_fma_f32 v136, v136, s31, -v192
    v_mfma_f32_16x16x32_bf16 v[112:115], a[164:167], v[152:155], v[112:115]
    v_exp_f32 v136, v136
    v_cvt_pk_bf16_f32 v131, v134, v135
    v_mfma_f32_16x16x32_bf16 v[116:119], a[168:171], v[144:147], 0
    ds_read_b64_tr_b16 a[148:149], v169 offset:8192
    ds_read_b64_tr_b16 a[150:151], v169 offset:12288
    v_fma_f32 v137, v137, s31, -v192
    v_mfma_f32_16x16x32_bf16 v[116:119], a[172:175], v[152:155], v[116:119]
    ds_read_b64_tr_b16 a[152:153], v169 offset:8
    v_exp_f32 v137, v137
    v_mfma_f32_16x16x32_bf16 v[120:123], a[176:179], v[144:147], 0
    ds_read_b64_tr_b16 a[154:155], v169 offset:4104
    ds_read_b64_tr_b16 a[156:157], v169 offset:8200
    v_fma_f32 v138, v138, s31, -v192
    v_mfma_f32_16x16x32_bf16 v[120:123], a[180:183], v[152:155], v[120:123]
    v_exp_f32 v138, v138
    v_mfma_f32_16x16x32_bf16 v[124:127], a[184:187], v[144:147], 0
    v_fma_f32 v139, v139, s31, -v192
    v_cvt_pk_bf16_f32 v136, v136, v137
    v_mfma_f32_16x16x32_bf16 v[124:127], a[188:191], v[152:155], v[124:127]
    v_exp_f32 v139, v139
    v_mfma_f32_16x16x32_bf16 a[204:207], a[208:211], v[144:147], 0
    ds_read_b64_tr_b16 a[158:159], v169 offset:12296
    v_fma_f32 v140, v140, s31, -v192
    v_mfma_f32_16x16x32_bf16 a[204:207], a[208:211], v[152:155], a[204:207]
    v_exp_f32 v140, v140
    v_cvt_pk_bf16_f32 v137, v138, v139
    v_mfma_f32_16x16x32_bf16 v[144:147], a[64:67], a[16:19], 0
    ds_read_b64_tr_b16 a[160:161], v170
    v_fma_f32 v141, v141, s31, -v192
    v_mfma_f32_16x16x32_bf16 v[144:147], a[68:71], a[20:23], v[144:147]
    v_exp_f32 v141, v141
    v_mfma_f32_16x16x32_bf16 v[144:147], a[72:75], a[24:27], v[144:147]
    v_fma_f32 v142, v142, s31, -v192
    v_cvt_pk_bf16_f32 v138, v140, v141
    v_mfma_f32_16x16x32_bf16 v[144:147], a[76:79], a[28:31], v[144:147]
    ds_read_b64_tr_b16 a[162:163], v170 offset:4096
    v_exp_f32 v142, v142
    v_mfma_f32_16x16x32_bf16 v[148:151], a[80:83], a[16:19], 0
    ds_read_b64_tr_b16 a[164:165], v170 offset:8192
    v_fma_f32 v143, v143, s31, -v192
    v_mfma_f32_16x16x32_bf16 v[148:151], a[84:87], a[20:23], v[148:151]
    ds_read_b64_tr_b16 a[166:167], v170 offset:12288
    v_exp_f32 v143, v143
    v_mfma_f32_16x16x32_bf16 v[148:151], a[88:91], a[24:27], v[148:151]
    buffer_store_dwordx4 a[220:223], v186, s[20:23], 0 offen offset:2048 sc1 nt
    v_mfma_f32_16x16x32_bf16 v[148:151], a[92:95], a[28:31], v[148:151]
    ds_read_b64_tr_b16 a[168:169], v170 offset:8
    ds_read_b64_tr_b16 a[170:171], v170 offset:4104
    ds_read_b64_tr_b16 a[172:173], v170 offset:8200
    v_mfma_f32_16x16x32_bf16 v[152:155], a[96:99], a[16:19], 0
    ds_read_b64_tr_b16 a[174:175], v170 offset:12296
    v_fma_f32 v144, v144, s31, -v193
    v_cvt_pk_bf16_f32 v139, v142, v143
    v_mfma_f32_16x16x32_bf16 v[152:155], a[100:103], a[20:23], v[152:155]
    v_exp_f32 v144, v144
    v_mfma_f32_16x16x32_bf16 v[152:155], a[104:107], a[24:27], v[152:155]
    ds_read_b64_tr_b16 a[176:177], v171
    ds_read_b64_tr_b16 a[178:179], v171 offset:4096
    v_fma_f32 v145, v145, s31, -v193
    v_mfma_f32_16x16x32_bf16 v[152:155], a[108:111], a[28:31], v[152:155]
    v_exp_f32 v145, v145
    v_mfma_f32_16x16x32_bf16 v[156:159], a[112:115], a[16:19], 0
    ds_read_b64_tr_b16 a[180:181], v171 offset:8192
    v_fma_f32 v146, v146, s31, -v193
    v_mfma_f32_16x16x32_bf16 v[156:159], a[116:119], a[20:23], v[156:159]
    v_exp_f32 v146, v146
    v_mfma_f32_16x16x32_bf16 v[156:159], a[120:123], a[24:27], v[156:159]
    ds_read_b64_tr_b16 a[182:183], v171 offset:12288
    v_fma_f32 v147, v147, s31, -v193
    v_mfma_f32_16x16x32_bf16 v[156:159], a[124:127], a[28:31], v[156:159]
    s_waitcnt lgkmcnt(15)
    v_exp_f32 v147, v147
    v_cvt_pk_bf16_f32 v144, v144, v145
    v_mfma_f32_16x16x32_bf16 v[0:3], a[128:131], v[128:131], v[0:3]
    v_fma_f32 v148, v148, s31, -v193
    v_add_u32 v160, s28, v160
    v_mfma_f32_16x16x32_bf16 v[0:3], a[132:135], v[136:139], v[0:3]
    v_exp_f32 v148, v148
    v_mfma_f32_16x16x32_bf16 v[4:7], a[136:139], v[128:131], v[4:7]
    ds_read_b64_tr_b16 a[184:185], v171 offset:8
    v_fma_f32 v149, v149, s31, -v193
    v_cvt_pk_bf16_f32 v145, v146, v147
    v_mfma_f32_16x16x32_bf16 v[4:7], a[140:143], v[136:139], v[4:7]
    v_exp_f32 v149, v149
    v_mfma_f32_16x16x32_bf16 v[8:11], a[144:147], v[128:131], v[8:11]
    v_fma_f32 v150, v150, s31, -v193
    v_cvt_pk_bf16_f32 v146, v148, v149
    v_mfma_f32_16x16x32_bf16 v[8:11], a[148:151], v[136:139], v[8:11]
    s_waitcnt lgkmcnt(13)
    v_exp_f32 v150, v150
    v_mfma_f32_16x16x32_bf16 v[12:15], a[152:155], v[128:131], v[12:15]
    ds_read_b64_tr_b16 a[186:187], v171 offset:4104
    v_fma_f32 v151, v151, s31, -v193
    v_mfma_f32_16x16x32_bf16 v[12:15], a[156:159], v[136:139], v[12:15]
    s_waitcnt lgkmcnt(10)
    ds_read_b64_tr_b16 a[188:189], v171 offset:8200
    ds_read_b64_tr_b16 a[190:191], v171 offset:12296
    v_exp_f32 v151, v151
    v_mfma_f32_16x16x32_bf16 v[16:19], a[160:163], v[128:131], v[16:19]
    v_fma_f32 v152, v152, s31, -v193
    v_add_u32 v163, s28, v163
    v_mfma_f32_16x16x32_bf16 v[16:19], a[164:167], v[136:139], v[16:19]
    s_waitcnt lgkmcnt(8)
    v_exp_f32 v152, v152
    v_mfma_f32_16x16x32_bf16 v[20:23], a[168:171], v[128:131], v[20:23]
    v_fma_f32 v153, v153, s31, -v193
    v_cvt_pk_bf16_f32 v147, v150, v151
    v_mfma_f32_16x16x32_bf16 v[20:23], a[172:175], v[136:139], v[20:23]
    s_waitcnt lgkmcnt(4)
    v_exp_f32 v153, v153
    v_mfma_f32_16x16x32_bf16 v[24:27], a[176:179], v[128:131], v[24:27]
    v_fma_f32 v154, v154, s31, -v193
    v_cvt_pk_bf16_f32 v152, v152, v153
    v_mfma_f32_16x16x32_bf16 v[24:27], a[180:183], v[136:139], v[24:27]
    s_waitcnt lgkmcnt(0)
    v_exp_f32 v154, v154
    v_mfma_f32_16x16x32_bf16 v[28:31], a[184:187], v[128:131], v[28:31]
    ds_read_b128 a[228:231], v190 offset:4096
    v_fma_f32 v155, v155, s31, -v193
    v_mfma_f32_16x16x32_bf16 v[28:31], a[188:191], v[136:139], v[28:31]
    v_exp_f32 v155, v155
    v_mfma_f32_16x16x32_bf16 a[192:195], a[208:211], v[128:131], a[192:195]
    ds_read_b128 a[232:235], v190 offset:5120
    v_fma_f32 v156, v156, s31, -v193
    v_mfma_f32_16x16x32_bf16 a[192:195], a[208:211], v[136:139], a[192:195]
    v_exp_f32 v156, v156
    v_add_u32 v168, s28, v168
    v_mfma_f32_16x16x32_bf16 v[128:131], a[64:67], a[32:35], 0
    v_fma_f32 v157, v157, s31, -v193
    v_cvt_pk_bf16_f32 v153, v154, v155
    v_mfma_f32_16x16x32_bf16 v[128:131], a[68:71], a[36:39], v[128:131]
    v_exp_f32 v157, v157
    v_mfma_f32_16x16x32_bf16 v[128:131], a[72:75], a[40:43], v[128:131]
    ds_read_b128 a[236:239], v190 offset:6144
    v_fma_f32 v158, v158, s31, -v193
    v_mfma_f32_16x16x32_bf16 v[128:131], a[76:79], a[44:47], v[128:131]
    v_exp_f32 v158, v158
    v_mfma_f32_16x16x32_bf16 v[132:135], a[80:83], a[32:35], 0
    v_fma_f32 v159, v159, s31, -v193
    v_cvt_pk_bf16_f32 v154, v156, v157
    v_mfma_f32_16x16x32_bf16 v[132:135], a[84:87], a[36:39], v[132:135]
    v_exp_f32 v159, v159
    v_mfma_f32_16x16x32_bf16 v[132:135], a[88:91], a[40:43], v[132:135]
    buffer_store_dwordx4 a[224:227], v187, s[20:23], 0 offen offset:3072 sc1 nt
    v_mfma_f32_16x16x32_bf16 v[132:135], a[92:95], a[44:47], v[132:135]
    v_cvt_pk_bf16_f32 v155, v158, v159
    v_add_u32 v169, s28, v169
    v_mfma_f32_16x16x32_bf16 v[136:139], a[96:99], a[32:35], 0
    v_fma_f32 v128, v128, s31, -v194
    v_add_u32 v162, s28, v162
    v_mfma_f32_16x16x32_bf16 v[136:139], a[100:103], a[36:39], v[136:139]
    v_exp_f32 v128, v128
    v_mfma_f32_16x16x32_bf16 v[136:139], a[104:107], a[40:43], v[136:139]
    v_fma_f32 v129, v129, s31, -v194
    v_add_u32 v161, s28, v161
    v_mfma_f32_16x16x32_bf16 v[136:139], a[108:111], a[44:47], v[136:139]
    v_exp_f32 v129, v129
    v_mfma_f32_16x16x32_bf16 v[140:143], a[112:115], a[32:35], 0
    ds_read_b128 a[240:243], v190 offset:7168
    v_fma_f32 v130, v130, s31, -v194
    v_mfma_f32_16x16x32_bf16 v[140:143], a[116:119], a[36:39], v[140:143]
    v_exp_f32 v130, v130
    v_mfma_f32_16x16x32_bf16 v[140:143], a[120:123], a[40:43], v[140:143]
    v_fma_f32 v131, v131, s31, -v194
    v_cvt_pk_bf16_f32 v128, v128, v129
    v_mfma_f32_16x16x32_bf16 v[140:143], a[124:127], a[44:47], v[140:143]
    v_exp_f32 v131, v131
    v_mfma_f32_16x16x32_bf16 v[32:35], a[128:131], v[144:147], v[32:35]
    v_fma_f32 v132, v132, s31, -v194
    v_cvt_pk_bf16_f32 v129, v130, v131
    v_mfma_f32_16x16x32_bf16 v[32:35], a[132:135], v[152:155], v[32:35]
    v_exp_f32 v132, v132
    v_mfma_f32_16x16x32_bf16 v[36:39], a[136:139], v[144:147], v[36:39]
    v_fma_f32 v133, v133, s31, -v194
    v_add_u32 v170, s28, v170
    v_mfma_f32_16x16x32_bf16 v[36:39], a[140:143], v[152:155], v[36:39]
    s_mov_b32 m0, s34
    v_exp_f32 v133, v133
    v_mfma_f32_16x16x32_bf16 v[40:43], a[144:147], v[144:147], v[40:43]
    buffer_load_dwordx4 v186, s[16:19], 0 offen offset:2048 nt lds
    v_fma_f32 v134, v134, s31, -v194
    v_mfma_f32_16x16x32_bf16 v[40:43], a[148:151], v[152:155], v[40:43]
    v_exp_f32 v134, v134
    v_mfma_f32_16x16x32_bf16 v[44:47], a[152:155], v[144:147], v[44:47]
    v_fma_f32 v135, v135, s31, -v194
    v_cvt_pk_bf16_f32 v130, v132, v133
    v_mfma_f32_16x16x32_bf16 v[44:47], a[156:159], v[152:155], v[44:47]
    v_exp_f32 v135, v135
    v_mfma_f32_16x16x32_bf16 v[48:51], a[160:163], v[144:147], v[48:51]
    v_fma_f32 v136, v136, s31, -v194
    v_add_u32 v171, s28, v171
    v_mfma_f32_16x16x32_bf16 v[48:51], a[164:167], v[152:155], v[48:51]
    v_exp_f32 v136, v136
    v_mfma_f32_16x16x32_bf16 v[52:55], a[168:171], v[144:147], v[52:55]
    v_fma_f32 v137, v137, s31, -v194
    v_cvt_pk_bf16_f32 v131, v134, v135
    v_mfma_f32_16x16x32_bf16 v[52:55], a[172:175], v[152:155], v[52:55]
    v_exp_f32 v137, v137
    v_mfma_f32_16x16x32_bf16 v[56:59], a[176:179], v[144:147], v[56:59]
    v_fma_f32 v138, v138, s31, -v194
    v_cvt_pk_bf16_f32 v136, v136, v137
    v_mfma_f32_16x16x32_bf16 v[56:59], a[180:183], v[152:155], v[56:59]
    s_mov_b32 m0, s34
    v_exp_f32 v138, v138
    v_mfma_f32_16x16x32_bf16 v[60:63], a[184:187], v[144:147], v[60:63]
    buffer_load_dwordx4 v187, s[16:19], 0 offen offset:3072 nt lds
    v_fma_f32 v139, v139, s31, -v194
    v_mfma_f32_16x16x32_bf16 v[60:63], a[188:191], v[152:155], v[60:63]
    v_exp_f32 v139, v139
    v_mfma_f32_16x16x32_bf16 a[196:199], a[208:211], v[144:147], a[196:199]
    s_add_u32 s27, s27, s28
    v_fma_f32 v140, v140, s31, -v194
    v_cvt_pk_bf16_f32 v137, v138, v139
    v_mfma_f32_16x16x32_bf16 a[196:199], a[208:211], v[152:155], a[196:199]
    v_exp_f32 v140, v140
    v_mfma_f32_16x16x32_bf16 v[144:147], a[64:67], a[48:51], 0
    v_fma_f32 v141, v141, s31, -v194
    s_waitcnt vmcnt(14)
    s_barrier
    v_mfma_f32_16x16x32_bf16 v[144:147], a[68:71], a[52:55], v[144:147]
    v_exp_f32 v141, v141
    v_mfma_f32_16x16x32_bf16 v[144:147], a[72:75], a[56:59], v[144:147]
    ds_read_b128 a[64:67], v160
    v_fma_f32 v142, v142, s31, -v194
    v_mfma_f32_16x16x32_bf16 v[144:147], a[76:79], a[60:63], v[144:147]
    v_exp_f32 v142, v142
    v_cvt_pk_bf16_f32 v138, v140, v141
    v_mfma_f32_16x16x32_bf16 v[148:151], a[80:83], a[48:51], 0
    ds_read_b128 a[68:71], v161
    v_fma_f32 v143, v143, s31, -v194
    v_mfma_f32_16x16x32_bf16 v[148:151], a[84:87], a[52:55], v[148:151]
    s_mov_b32 m0, s29
    v_exp_f32 v143, v143
    v_mfma_f32_16x16x32_bf16 v[148:151], a[88:91], a[56:59], v[148:151]
    buffer_load_dwordx4 v184, s[8:11], s25 offen nt lds
    v_cvt_pk_bf16_f32 v139, v142, v143
    v_mfma_f32_16x16x32_bf16 v[148:151], a[92:95], a[60:63], v[148:151]
    buffer_load_dwordx4 v185, s[8:11], s25 offen offset:1024 nt lds
    v_mfma_f32_16x16x32_bf16 v[152:155], a[96:99], a[48:51], 0
    buffer_load_dwordx4 v186, s[8:11], s25 offen offset:2048 nt lds
    v_fma_f32 v144, v144, s31, -v195
    v_mfma_f32_16x16x32_bf16 v[152:155], a[100:103], a[52:55], v[152:155]
    ds_read_b128 a[72:75], v162
    ds_read_b128 a[76:79], v163
    v_exp_f32 v144, v144
    v_mfma_f32_16x16x32_bf16 v[152:155], a[104:107], a[56:59], v[152:155]
    ds_read_b128 a[80:83], v160 offset:4096
    v_fma_f32 v145, v145, s31, -v195
    v_mfma_f32_16x16x32_bf16 v[152:155], a[108:111], a[60:63], v[152:155]
    ds_read_b128 a[84:87], v161 offset:4096
    v_exp_f32 v145, v145
    v_mfma_f32_16x16x32_bf16 v[156:159], a[112:115], a[48:51], 0
    v_fma_f32 v146, v146, s31, -v195
    v_cvt_pk_bf16_f32 v144, v144, v145
    v_mfma_f32_16x16x32_bf16 v[156:159], a[116:119], a[52:55], v[156:159]
    v_exp_f32 v146, v146
    v_mfma_f32_16x16x32_bf16 v[156:159], a[120:123], a[56:59], v[156:159]
    ds_read_b128 a[88:91], v162 offset:4096
    buffer_load_dwordx4 v187, s[8:11], s25 offen offset:3072 nt lds
    v_fma_f32 v147, v147, s31, -v195
    v_mfma_f32_16x16x32_bf16 v[156:159], a[124:127], a[60:63], v[156:159]
    s_add_u32 m0, s29, 49152
    ds_read_b128 a[92:95], v163 offset:4096
    v_exp_f32 v147, v147
    v_mfma_f32_16x16x32_bf16 v[64:67], a[128:131], v[128:131], v[64:67]
    buffer_load_dwordx4 v188, s[12:15], s25 offen nt lds
    v_fma_f32 v148, v148, s31, -v195
    v_mfma_f32_16x16x32_bf16 v[64:67], a[132:135], v[136:139], v[64:67]
    ds_read_b128 a[96:99], v160 offset:8192
    v_exp_f32 v148, v148
    v_mfma_f32_16x16x32_bf16 v[68:71], a[136:139], v[128:131], v[68:71]
    buffer_load_dwordx4 v188, s[12:15], s25 offen offset:1024 nt lds
    v_fma_f32 v149, v149, s31, -v195
    v_mfma_f32_16x16x32_bf16 v[68:71], a[140:143], v[136:139], v[68:71]
    v_exp_f32 v149, v149
    v_cvt_pk_bf16_f32 v145, v146, v147
    v_mfma_f32_16x16x32_bf16 v[72:75], a[144:147], v[128:131], v[72:75]
    buffer_load_dwordx4 v188, s[12:15], s25 offen offset:2048 nt lds
    v_fma_f32 v150, v150, s31, -v195
    v_cvt_pk_bf16_f32 v146, v148, v149
    v_mfma_f32_16x16x32_bf16 v[72:75], a[148:151], v[136:139], v[72:75]
    ds_read_b128 a[100:103], v161 offset:8192
    ds_read_b128 a[104:107], v162 offset:8192
    v_exp_f32 v150, v150
    v_mfma_f32_16x16x32_bf16 v[76:79], a[152:155], v[128:131], v[76:79]
    ds_read_b128 a[108:111], v163 offset:8192
    v_fma_f32 v151, v151, s31, -v195
    v_mfma_f32_16x16x32_bf16 v[76:79], a[156:159], v[136:139], v[76:79]
    v_exp_f32 v151, v151
    v_mfma_f32_16x16x32_bf16 v[80:83], a[160:163], v[128:131], v[80:83]
    buffer_load_dwordx4 v188, s[12:15], s25 offen offset:3072 nt lds
    v_fma_f32 v152, v152, s31, -v195
    v_mfma_f32_16x16x32_bf16 v[80:83], a[164:167], v[136:139], v[80:83]
    v_exp_f32 v152, v152
    v_mfma_f32_16x16x32_bf16 v[84:87], a[168:171], v[128:131], v[84:87]
    v_fma_f32 v153, v153, s31, -v195
    v_cvt_pk_bf16_f32 v147, v150, v151
    v_mfma_f32_16x16x32_bf16 v[84:87], a[172:175], v[136:139], v[84:87]
    v_exp_f32 v153, v153
    v_mfma_f32_16x16x32_bf16 v[88:91], a[176:179], v[128:131], v[88:91]
    v_fma_f32 v154, v154, s31, -v195
    v_cvt_pk_bf16_f32 v152, v152, v153
    v_mfma_f32_16x16x32_bf16 v[88:91], a[180:183], v[136:139], v[88:91]
    ds_read_b128 a[112:115], v160 offset:12288
    v_exp_f32 v154, v154
    v_mfma_f32_16x16x32_bf16 v[92:95], a[184:187], v[128:131], v[92:95]
    ds_read_b128 a[116:119], v161 offset:12288
    v_fma_f32 v155, v155, s31, -v195
    v_mfma_f32_16x16x32_bf16 v[92:95], a[188:191], v[136:139], v[92:95]
    v_exp_f32 v155, v155
    v_mfma_f32_16x16x32_bf16 a[200:203], a[208:211], v[128:131], a[200:203]
    ds_read_b128 a[120:123], v162 offset:12288
    ds_read_b128 a[124:127], v163 offset:12288
    v_fma_f32 v156, v156, s31, -v195
    v_mfma_f32_16x16x32_bf16 a[200:203], a[208:211], v[136:139], a[200:203]
    s_waitcnt lgkmcnt(12)
    v_exp_f32 v156, v156
    v_mfma_f32_16x16x32_bf16 v[128:131], a[64:67], a[0:3], 0
    v_fma_f32 v157, v157, s31, -v195
    v_cvt_pk_bf16_f32 v153, v154, v155
    v_mfma_f32_16x16x32_bf16 v[128:131], a[68:71], a[4:7], v[128:131]
    s_add_u32 s4, s4, 16384
    v_exp_f32 v157, v157
    v_mfma_f32_16x16x32_bf16 v[128:131], a[72:75], a[8:11], v[128:131]
    s_and_b32 s4, s4, 0x1ffff
    v_fma_f32 v158, v158, s31, -v195
    v_mfma_f32_16x16x32_bf16 v[128:131], a[76:79], a[12:15], v[128:131]
    s_waitcnt lgkmcnt(8)
    v_exp_f32 v158, v158
    v_mfma_f32_16x16x32_bf16 v[132:135], a[80:83], a[0:3], 0
    v_fma_f32 v159, v159, s31, -v195
    v_cvt_pk_bf16_f32 v154, v156, v157
    v_mfma_f32_16x16x32_bf16 v[132:135], a[84:87], a[4:7], v[132:135]
    s_add_u32 s25, s3, s4
    v_exp_f32 v159, v159
    v_mfma_f32_16x16x32_bf16 v[132:135], a[88:91], a[8:11], v[132:135]
    v_mfma_f32_16x16x32_bf16 v[132:135], a[92:95], a[12:15], v[132:135]
    s_waitcnt lgkmcnt(4)
    v_cvt_pk_bf16_f32 v155, v158, v159
    v_mfma_f32_16x16x32_bf16 v[136:139], a[96:99], a[0:3], 0
    v_fma_f32 v128, v128, s31, -v192
    v_mfma_f32_16x16x32_bf16 v[136:139], a[100:103], a[4:7], v[136:139]
    s_add_u32 s39, s27, 16384
    v_exp_f32 v128, v128
    v_mfma_f32_16x16x32_bf16 v[136:139], a[104:107], a[8:11], v[136:139]
    v_fma_f32 v129, v129, s31, -v192
    v_mfma_f32_16x16x32_bf16 v[136:139], a[108:111], a[12:15], v[136:139]
    s_waitcnt lgkmcnt(0)
    v_exp_f32 v129, v129
    v_mfma_f32_16x16x32_bf16 v[140:143], a[112:115], a[0:3], 0
    v_fma_f32 v130, v130, s31, -v192
    v_cvt_pk_bf16_f32 v128, v128, v129
    v_mfma_f32_16x16x32_bf16 v[140:143], a[116:119], a[4:7], v[140:143]
    s_cmp_eq_u32 s39, 49152
    s_cselect_b32 s39, 0, s39
    v_exp_f32 v130, v130
    v_mfma_f32_16x16x32_bf16 v[140:143], a[120:123], a[8:11], v[140:143]
    s_sub_u32 s28, s39, s27
    v_fma_f32 v131, v131, s31, -v192
    v_mfma_f32_16x16x32_bf16 v[140:143], a[124:127], a[12:15], v[140:143]
    v_exp_f32 v131, v131
    v_mfma_f32_16x16x32_bf16 v[96:99], a[128:131], v[144:147], v[96:99]
    v_fma_f32 v132, v132, s31, -v192
    v_cvt_pk_bf16_f32 v129, v130, v131
    v_mfma_f32_16x16x32_bf16 v[96:99], a[132:135], v[152:155], v[96:99]
    v_exp_f32 v132, v132
    v_mfma_f32_16x16x32_bf16 v[100:103], a[136:139], v[144:147], v[100:103]
    ds_read_b64_tr_b16 a[128:129], v168
    v_fma_f32 v133, v133, s31, -v192
    v_mfma_f32_16x16x32_bf16 v[100:103], a[140:143], v[152:155], v[100:103]
    v_exp_f32 v133, v133
    v_mfma_f32_16x16x32_bf16 v[104:107], a[144:147], v[144:147], v[104:107]
    s_add_u32 s29, s27, s50
    ds_read_b64_tr_b16 a[130:131], v168 offset:4096
    v_fma_f32 v134, v134, s31, -v192
    v_mfma_f32_16x16x32_bf16 v[104:107], a[148:151], v[152:155], v[104:107]
    ds_read_b64_tr_b16 a[132:133], v168 offset:8192
    v_exp_f32 v134, v134
    v_mfma_f32_16x16x32_bf16 v[108:111], a[152:155], v[144:147], v[108:111]
    ds_read_b64_tr_b16 a[134:135], v168 offset:12288
    ds_read_b64_tr_b16 a[136:137], v168 offset:8
    v_fma_f32 v135, v135, s31, -v192
    v_mfma_f32_16x16x32_bf16 v[108:111], a[156:159], v[152:155], v[108:111]
    v_exp_f32 v135, v135
    v_cvt_pk_bf16_f32 v130, v132, v133
    v_mfma_f32_16x16x32_bf16 v[112:115], a[160:163], v[144:147], v[112:115]
    ds_read_b64_tr_b16 a[138:139], v168 offset:4104
    ds_read_b64_tr_b16 a[140:141], v168 offset:8200
    v_fma_f32 v136, v136, s31, -v192
    v_mfma_f32_16x16x32_bf16 v[112:115], a[164:167], v[152:155], v[112:115]
    v_exp_f32 v136, v136
    v_mfma_f32_16x16x32_bf16 v[116:119], a[168:171], v[144:147], v[116:119]
    v_fma_f32 v137, v137, s31, -v192
    v_cvt_pk_bf16_f32 v131, v134, v135
    v_mfma_f32_16x16x32_bf16 v[116:119], a[172:175], v[152:155], v[116:119]
    v_exp_f32 v137, v137
    v_mfma_f32_16x16x32_bf16 v[120:123], a[176:179], v[144:147], v[120:123]
    v_fma_f32 v138, v138, s31, -v192
    v_cvt_pk_bf16_f32 v136, v136, v137
    v_mfma_f32_16x16x32_bf16 v[120:123], a[180:183], v[152:155], v[120:123]
    v_exp_f32 v138, v138
    v_mfma_f32_16x16x32_bf16 v[124:127], a[184:187], v[144:147], v[124:127]
    ds_read_b64_tr_b16 a[142:143], v168 offset:12296
    ds_read_b64_tr_b16 a[144:145], v169
    v_fma_f32 v139, v139, s31, -v192
    v_mfma_f32_16x16x32_bf16 v[124:127], a[188:191], v[152:155], v[124:127]
    v_exp_f32 v139, v139
    v_mfma_f32_16x16x32_bf16 a[204:207], a[208:211], v[144:147], a[204:207]
    v_fma_f32 v140, v140, s31, -v192
    v_cvt_pk_bf16_f32 v137, v138, v139
    v_mfma_f32_16x16x32_bf16 a[204:207], a[208:211], v[152:155], a[204:207]
    v_exp_f32 v140, v140
    v_mfma_f32_16x16x32_bf16 v[144:147], a[64:67], a[16:19], 0
    ds_read_b64_tr_b16 a[146:147], v169 offset:4096
    ds_read_b64_tr_b16 a[148:149], v169 offset:8192
    v_fma_f32 v141, v141, s31, -v192
    v_mfma_f32_16x16x32_bf16 v[144:147], a[68:71], a[20:23], v[144:147]
    ds_read_b64_tr_b16 a[150:151], v169 offset:12288
    v_exp_f32 v141, v141
    v_mfma_f32_16x16x32_bf16 v[144:147], a[72:75], a[24:27], v[144:147]
    ds_read_b64_tr_b16 a[152:153], v169 offset:8
    v_fma_f32 v142, v142, s31, -v192
    v_mfma_f32_16x16x32_bf16 v[144:147], a[76:79], a[28:31], v[144:147]
    ds_read_b64_tr_b16 a[154:155], v169 offset:4104
    v_exp_f32 v142, v142
    v_mfma_f32_16x16x32_bf16 v[148:151], a[80:83], a[16:19], 0
    ds_read_b64_tr_b16 a[156:157], v169 offset:8200
    v_fma_f32 v143, v143, s31, -v192
    v_cvt_pk_bf16_f32 v138, v140, v141
    v_mfma_f32_16x16x32_bf16 v[148:151], a[84:87], a[20:23], v[148:151]
    v_exp_f32 v143, v143
    v_mfma_f32_16x16x32_bf16 v[148:151], a[88:91], a[24:27], v[148:151]
    buffer_store_dwordx4 a[228:231], v184, s[20:23], s36 offen sc1 nt
    v_mfma_f32_16x16x32_bf16 v[148:151], a[92:95], a[28:31], v[148:151]
    ds_read_b64_tr_b16 a[158:159], v169 offset:12296
    ds_read_b64_tr_b16 a[160:161], v170
    v_mfma_f32_16x16x32_bf16 v[152:155], a[96:99], a[16:19], 0
    v_fma_f32 v144, v144, s31, -v193
    v_cvt_pk_bf16_f32 v139, v142, v143
    v_mfma_f32_16x16x32_bf16 v[152:155], a[100:103], a[20:23], v[152:155]
    v_exp_f32 v144, v144
    v_mfma_f32_16x16x32_bf16 v[152:155], a[104:107], a[24:27], v[152:155]
    ds_read_b64_tr_b16 a[162:163], v170 offset:4096
    ds_read_b64_tr_b16 a[164:165], v170 offset:8192
    v_fma_f32 v145, v145, s31, -v193
    v_mfma_f32_16x16x32_bf16 v[152:155], a[108:111], a[28:31], v[152:155]
    v_exp_f32 v145, v145
    v_mfma_f32_16x16x32_bf16 v[156:159], a[112:115], a[16:19], 0
    ds_read_b64_tr_b16 a[166:167], v170 offset:12288
    v_fma_f32 v146, v146, s31, -v193
    v_cvt_pk_bf16_f32 v144, v144, v145
    v_mfma_f32_16x16x32_bf16 v[156:159], a[116:119], a[20:23], v[156:159]
    ds_read_b64_tr_b16 a[168:169], v170 offset:8
    v_exp_f32 v146, v146
    v_mfma_f32_16x16x32_bf16 v[156:159], a[120:123], a[24:27], v[156:159]
    ds_read_b64_tr_b16 a[170:171], v170 offset:4104
    ds_read_b64_tr_b16 a[172:173], v170 offset:8200
    v_fma_f32 v147, v147, s31, -v193
    v_mfma_f32_16x16x32_bf16 v[156:159], a[124:127], a[28:31], v[156:159]
    s_waitcnt lgkmcnt(15)
    v_exp_f32 v147, v147
    v_mfma_f32_16x16x32_bf16 v[0:3], a[128:131], v[128:131], v[0:3]
    ds_read_b64_tr_b16 a[174:175], v170 offset:12296
    ds_read_b64_tr_b16 a[176:177], v171
    v_fma_f32 v148, v148, s31, -v193
    v_mfma_f32_16x16x32_bf16 v[0:3], a[132:135], v[136:139], v[0:3]
    v_exp_f32 v148, v148
    v_mfma_f32_16x16x32_bf16 v[4:7], a[136:139], v[128:131], v[4:7]
    ds_read_b64_tr_b16 a[178:179], v171 offset:4096
    v_fma_f32 v149, v149, s31, -v193
    v_cvt_pk_bf16_f32 v145, v146, v147
    v_mfma_f32_16x16x32_bf16 v[4:7], a[140:143], v[136:139], v[4:7]
    s_waitcnt lgkmcnt(14)
    v_exp_f32 v149, v149
    v_mfma_f32_16x16x32_bf16 v[8:11], a[144:147], v[128:131], v[8:11]
    ds_read_b64_tr_b16 a[180:181], v171 offset:8192
    v_fma_f32 v150, v150, s31, -v193
    v_cvt_pk_bf16_f32 v146, v148, v149
    v_mfma_f32_16x16x32_bf16 v[8:11], a[148:151], v[136:139], v[8:11]
    s_waitcnt lgkmcnt(11)
    ds_read_b64_tr_b16 a[182:183], v171 offset:12288
    v_exp_f32 v150, v150
    v_mfma_f32_16x16x32_bf16 v[12:15], a[152:155], v[128:131], v[12:15]
    ds_read_b64_tr_b16 a[184:185], v171 offset:8
    ds_read_b64_tr_b16 a[186:187], v171 offset:4104
    v_fma_f32 v151, v151, s31, -v193
    v_mfma_f32_16x16x32_bf16 v[12:15], a[156:159], v[136:139], v[12:15]
    s_waitcnt lgkmcnt(10)
    v_exp_f32 v151, v151
    v_mfma_f32_16x16x32_bf16 v[16:19], a[160:163], v[128:131], v[16:19]
    ds_read_b64_tr_b16 a[188:189], v171 offset:8200
    v_fma_f32 v152, v152, s31, -v193
    v_mfma_f32_16x16x32_bf16 v[16:19], a[164:167], v[136:139], v[16:19]
    s_waitcnt lgkmcnt(7)
    ds_read_b64_tr_b16 a[190:191], v171 offset:12296
    v_exp_f32 v152, v152
    v_mfma_f32_16x16x32_bf16 v[20:23], a[168:171], v[128:131], v[20:23]
    v_fma_f32 v153, v153, s31, -v193
    v_cvt_pk_bf16_f32 v147, v150, v151
    v_mfma_f32_16x16x32_bf16 v[20:23], a[172:175], v[136:139], v[20:23]
    s_waitcnt lgkmcnt(4)
    v_exp_f32 v153, v153
    v_mfma_f32_16x16x32_bf16 v[24:27], a[176:179], v[128:131], v[24:27]
    v_fma_f32 v154, v154, s31, -v193
    v_cvt_pk_bf16_f32 v152, v152, v153
    v_mfma_f32_16x16x32_bf16 v[24:27], a[180:183], v[136:139], v[24:27]
    s_waitcnt lgkmcnt(0)
    v_exp_f32 v154, v154
    v_mfma_f32_16x16x32_bf16 v[28:31], a[184:187], v[128:131], v[28:31]
    ds_read_b128 a[212:215], v190 offset:8192
    v_fma_f32 v155, v155, s31, -v193
    v_mfma_f32_16x16x32_bf16 v[28:31], a[188:191], v[136:139], v[28:31]
    v_exp_f32 v155, v155
    v_mfma_f32_16x16x32_bf16 a[192:195], a[208:211], v[128:131], a[192:195]
    ds_read_b128 a[216:219], v190 offset:9216
    v_fma_f32 v156, v156, s31, -v193
    v_mfma_f32_16x16x32_bf16 a[192:195], a[208:211], v[136:139], a[192:195]
    v_exp_f32 v156, v156
    v_mfma_f32_16x16x32_bf16 v[128:131], a[64:67], a[32:35], 0
    v_fma_f32 v157, v157, s31, -v193
    v_cvt_pk_bf16_f32 v153, v154, v155
    v_mfma_f32_16x16x32_bf16 v[128:131], a[68:71], a[36:39], v[128:131]
    ds_read_b128 a[220:223], v190 offset:10240
    v_exp_f32 v157, v157
    v_mfma_f32_16x16x32_bf16 v[128:131], a[72:75], a[40:43], v[128:131]
    v_fma_f32 v158, v158, s31, -v193
    v_cvt_pk_bf16_f32 v154, v156, v157
    v_mfma_f32_16x16x32_bf16 v[128:131], a[76:79], a[44:47], v[128:131]
    v_exp_f32 v158, v158
    v_mfma_f32_16x16x32_bf16 v[132:135], a[80:83], a[32:35], 0
    ds_read_b128 a[224:227], v190 offset:11264
    v_fma_f32 v159, v159, s31, -v193
    v_mfma_f32_16x16x32_bf16 v[132:135], a[84:87], a[36:39], v[132:135]
    v_exp_f32 v159, v159
    v_mfma_f32_16x16x32_bf16 v[132:135], a[88:91], a[40:43], v[132:135]
    v_add_u32 v161, s28, v161
    v_add_u32 v163, s28, v163
    v_mfma_f32_16x16x32_bf16 v[132:135], a[92:95], a[44:47], v[132:135]
    v_cvt_pk_bf16_f32 v155, v158, v159
    v_add_u32 v162, s28, v162
    v_mfma_f32_16x16x32_bf16 v[136:139], a[96:99], a[32:35], 0
    v_fma_f32 v128, v128, s31, -v194
    v_add_u32 v168, s28, v168
    v_mfma_f32_16x16x32_bf16 v[136:139], a[100:103], a[36:39], v[136:139]
    v_exp_f32 v128, v128
    v_mfma_f32_16x16x32_bf16 v[136:139], a[104:107], a[40:43], v[136:139]
    v_fma_f32 v129, v129, s31, -v194
    v_add_u32 v160, s28, v160
    v_mfma_f32_16x16x32_bf16 v[136:139], a[108:111], a[44:47], v[136:139]
    v_exp_f32 v129, v129
    v_mfma_f32_16x16x32_bf16 v[140:143], a[112:115], a[32:35], 0
    v_fma_f32 v130, v130, s31, -v194
    v_cvt_pk_bf16_f32 v128, v128, v129
    v_mfma_f32_16x16x32_bf16 v[140:143], a[116:119], a[36:39], v[140:143]
    v_exp_f32 v130, v130
    v_mfma_f32_16x16x32_bf16 v[140:143], a[120:123], a[40:43], v[140:143]
    v_fma_f32 v131, v131, s31, -v194
    v_add_u32 v169, s28, v169
    v_mfma_f32_16x16x32_bf16 v[140:143], a[124:127], a[44:47], v[140:143]
    s_add_u32 m0, s34, 4096
    v_exp_f32 v131, v131
    v_mfma_f32_16x16x32_bf16 v[32:35], a[128:131], v[144:147], v[32:35]
    buffer_load_dwordx4 v184, s[16:19], s36 offen nt lds
    v_fma_f32 v132, v132, s31, -v194
    v_mfma_f32_16x16x32_bf16 v[32:35], a[132:135], v[152:155], v[32:35]
    v_exp_f32 v132, v132
    v_mfma_f32_16x16x32_bf16 v[36:39], a[136:139], v[144:147], v[36:39]
    v_fma_f32 v133, v133, s31, -v194
    v_cvt_pk_bf16_f32 v129, v130, v131
    v_mfma_f32_16x16x32_bf16 v[36:39], a[140:143], v[152:155], v[36:39]
    v_exp_f32 v133, v133
    v_mfma_f32_16x16x32_bf16 v[40:43], a[144:147], v[144:147], v[40:43]
    v_fma_f32 v134, v134, s31, -v194
    v_add_u32 v171, s28, v171
    v_mfma_f32_16x16x32_bf16 v[40:43], a[148:151], v[152:155], v[40:43]
    v_exp_f32 v134, v134
    v_mfma_f32_16x16x32_bf16 v[44:47], a[152:155], v[144:147], v[44:47]
    v_fma_f32 v135, v135, s31, -v194
    v_cvt_pk_bf16_f32 v130, v132, v133
    v_mfma_f32_16x16x32_bf16 v[44:47], a[156:159], v[152:155], v[44:47]
    v_exp_f32 v135, v135
    v_mfma_f32_16x16x32_bf16 v[48:51], a[160:163], v[144:147], v[48:51]
    buffer_store_dwordx4 a[232:235], v185, s[20:23], s36 offen offset:1024 sc1 nt
    v_fma_f32 v136, v136, s31, -v194
    v_mfma_f32_16x16x32_bf16 v[48:51], a[164:167], v[152:155], v[48:51]
    v_exp_f32 v136, v136
    v_mfma_f32_16x16x32_bf16 v[52:55], a[168:171], v[144:147], v[52:55]
    v_fma_f32 v137, v137, s31, -v194
    v_cvt_pk_bf16_f32 v131, v134, v135
    v_mfma_f32_16x16x32_bf16 v[52:55], a[172:175], v[152:155], v[52:55]
    v_exp_f32 v137, v137
    v_add_u32 v170, s28, v170
    v_mfma_f32_16x16x32_bf16 v[56:59], a[176:179], v[144:147], v[56:59]
    v_fma_f32 v138, v138, s31, -v194
    v_cvt_pk_bf16_f32 v136, v136, v137
    v_mfma_f32_16x16x32_bf16 v[56:59], a[180:183], v[152:155], v[56:59]
    s_add_u32 m0, s34, 4096
    v_exp_f32 v138, v138
    v_mfma_f32_16x16x32_bf16 v[60:63], a[184:187], v[144:147], v[60:63]
    buffer_load_dwordx4 v185, s[16:19], s36 offen offset:1024 nt lds
    v_fma_f32 v139, v139, s31, -v194
    v_mfma_f32_16x16x32_bf16 v[60:63], a[188:191], v[152:155], v[60:63]
    v_exp_f32 v139, v139
    v_mfma_f32_16x16x32_bf16 a[196:199], a[208:211], v[144:147], a[196:199]
    s_add_u32 s27, s27, s28
    v_fma_f32 v140, v140, s31, -v194
    v_cvt_pk_bf16_f32 v137, v138, v139
    v_mfma_f32_16x16x32_bf16 a[196:199], a[208:211], v[152:155], a[196:199]
    v_exp_f32 v140, v140
    v_mfma_f32_16x16x32_bf16 v[144:147], a[64:67], a[48:51], 0
    v_fma_f32 v141, v141, s31, -v194
    s_waitcnt vmcnt(16)
    s_barrier
    v_mfma_f32_16x16x32_bf16 v[144:147], a[68:71], a[52:55], v[144:147]
    s_mov_b32 m0, s29
    v_exp_f32 v141, v141
    v_mfma_f32_16x16x32_bf16 v[144:147], a[72:75], a[56:59], v[144:147]
    buffer_load_dwordx4 v184, s[8:11], s25 offen nt lds
    v_fma_f32 v142, v142, s31, -v194
    v_mfma_f32_16x16x32_bf16 v[144:147], a[76:79], a[60:63], v[144:147]
    v_exp_f32 v142, v142
    v_cvt_pk_bf16_f32 v138, v140, v141
    v_mfma_f32_16x16x32_bf16 v[148:151], a[80:83], a[48:51], 0
    ds_read_b128 a[64:67], v160
    v_fma_f32 v143, v143, s31, -v194
    v_mfma_f32_16x16x32_bf16 v[148:151], a[84:87], a[52:55], v[148:151]
    ds_read_b128 a[68:71], v161
    v_exp_f32 v143, v143
    v_mfma_f32_16x16x32_bf16 v[148:151], a[88:91], a[56:59], v[148:151]
    ds_read_b128 a[72:75], v162
    buffer_load_dwordx4 v185, s[8:11], s25 offen offset:1024 nt lds
    v_mfma_f32_16x16x32_bf16 v[148:151], a[92:95], a[60:63], v[148:151]
    buffer_load_dwordx4 v186, s[8:11], s25 offen offset:2048 nt lds
    v_cvt_pk_bf16_f32 v139, v142, v143
    v_mfma_f32_16x16x32_bf16 v[152:155], a[96:99], a[48:51], 0
    buffer_load_dwordx4 v187, s[8:11], s25 offen offset:3072 nt lds
    v_fma_f32 v144, v144, s31, -v195
    v_mfma_f32_16x16x32_bf16 v[152:155], a[100:103], a[52:55], v[152:155]
    ds_read_b128 a[76:79], v163
    v_exp_f32 v144, v144
    v_mfma_f32_16x16x32_bf16 v[152:155], a[104:107], a[56:59], v[152:155]
    ds_read_b128 a[80:83], v160 offset:4096
    v_fma_f32 v145, v145, s31, -v195
    v_mfma_f32_16x16x32_bf16 v[152:155], a[108:111], a[60:63], v[152:155]
    v_exp_f32 v145, v145
    v_mfma_f32_16x16x32_bf16 v[156:159], a[112:115], a[48:51], 0
    ds_read_b128 a[84:87], v161 offset:4096
    v_fma_f32 v146, v146, s31, -v195
    v_cvt_pk_bf16_f32 v144, v144, v145
    v_mfma_f32_16x16x32_bf16 v[156:159], a[116:119], a[52:55], v[156:159]
    s_add_u32 m0, s29, 49152
    v_exp_f32 v146, v146
    v_mfma_f32_16x16x32_bf16 v[156:159], a[120:123], a[56:59], v[156:159]
    buffer_load_dwordx4 v188, s[12:15], s25 offen nt lds
    v_fma_f32 v147, v147, s31, -v195
    v_mfma_f32_16x16x32_bf16 v[156:159], a[124:127], a[60:63], v[156:159]
    ds_read_b128 a[88:91], v162 offset:4096
    v_exp_f32 v147, v147
    v_mfma_f32_16x16x32_bf16 v[64:67], a[128:131], v[128:131], v[64:67]
    buffer_load_dwordx4 v188, s[12:15], s25 offen offset:1024 nt lds
    v_fma_f32 v148, v148, s31, -v195
    v_mfma_f32_16x16x32_bf16 v[64:67], a[132:135], v[136:139], v[64:67]
    v_exp_f32 v148, v148
    v_mfma_f32_16x16x32_bf16 v[68:71], a[136:139], v[128:131], v[68:71]
    ds_read_b128 a[92:95], v163 offset:4096
    v_fma_f32 v149, v149, s31, -v195
    v_mfma_f32_16x16x32_bf16 v[68:71], a[140:143], v[136:139], v[68:71]
    v_exp_f32 v149, v149
    v_cvt_pk_bf16_f32 v145, v146, v147
    v_mfma_f32_16x16x32_bf16 v[72:75], a[144:147], v[128:131], v[72:75]
    ds_read_b128 a[96:99], v160 offset:8192
    ds_read_b128 a[100:103], v161 offset:8192
    v_fma_f32 v150, v150, s31, -v195
    v_mfma_f32_16x16x32_bf16 v[72:75], a[148:151], v[136:139], v[72:75]
    ds_read_b128 a[104:107], v162 offset:8192
    v_exp_f32 v150, v150
    v_mfma_f32_16x16x32_bf16 v[76:79], a[152:155], v[128:131], v[76:79]
    buffer_load_dwordx4 v188, s[12:15], s25 offen offset:2048 nt lds
    v_fma_f32 v151, v151, s31, -v195
    v_mfma_f32_16x16x32_bf16 v[76:79], a[156:159], v[136:139], v[76:79]
    v_exp_f32 v151, v151
    v_cvt_pk_bf16_f32 v146, v148, v149
    v_mfma_f32_16x16x32_bf16 v[80:83], a[160:163], v[128:131], v[80:83]
    buffer_load_dwordx4 v188, s[12:15], s25 offen offset:3072 nt lds
    v_fma_f32 v152, v152, s31, -v195
    v_cvt_pk_bf16_f32 v147, v150, v151
    v_mfma_f32_16x16x32_bf16 v[80:83], a[164:167], v[136:139], v[80:83]
    v_exp_f32 v152, v152
    v_mfma_f32_16x16x32_bf16 v[84:87], a[168:171], v[128:131], v[84:87]
    ds_read_b128 a[108:111], v163 offset:8192
    v_fma_f32 v153, v153, s31, -v195
    v_mfma_f32_16x16x32_bf16 v[84:87], a[172:175], v[136:139], v[84:87]
    ds_read_b128 a[112:115], v160 offset:12288
    v_exp_f32 v153, v153
    v_mfma_f32_16x16x32_bf16 v[88:91], a[176:179], v[128:131], v[88:91]
    ds_read_b128 a[116:119], v161 offset:12288
    v_fma_f32 v154, v154, s31, -v195
    v_mfma_f32_16x16x32_bf16 v[88:91], a[180:183], v[136:139], v[88:91]
    v_exp_f32 v154, v154
    v_mfma_f32_16x16x32_bf16 v[92:95], a[184:187], v[128:131], v[92:95]
    ds_read_b128 a[120:123], v162 offset:12288
    v_fma_f32 v155, v155, s31, -v195
    v_cvt_pk_bf16_f32 v152, v152, v153
    v_mfma_f32_16x16x32_bf16 v[92:95], a[188:191], v[136:139], v[92:95]
    v_exp_f32 v155, v155
    v_mfma_f32_16x16x32_bf16 a[200:203], a[208:211], v[128:131], a[200:203]
    ds_read_b128 a[124:127], v163 offset:12288
    v_fma_f32 v156, v156, s31, -v195
    v_mfma_f32_16x16x32_bf16 a[200:203], a[208:211], v[136:139], a[200:203]
    s_waitcnt lgkmcnt(12)
    v_exp_f32 v156, v156
    v_mfma_f32_16x16x32_bf16 v[128:131], a[64:67], a[0:3], 0
    v_fma_f32 v157, v157, s31, -v195
    v_cvt_pk_bf16_f32 v153, v154, v155
    v_mfma_f32_16x16x32_bf16 v[128:131], a[68:71], a[4:7], v[128:131]
    s_add_u32 s4, s4, 16384
    v_exp_f32 v157, v157
    v_mfma_f32_16x16x32_bf16 v[128:131], a[72:75], a[8:11], v[128:131]
    s_and_b32 s4, s4, 0x1ffff
    v_fma_f32 v158, v158, s31, -v195
    v_mfma_f32_16x16x32_bf16 v[128:131], a[76:79], a[12:15], v[128:131]
    s_waitcnt lgkmcnt(8)
    v_exp_f32 v158, v158
    v_mfma_f32_16x16x32_bf16 v[132:135], a[80:83], a[0:3], 0
    v_fma_f32 v159, v159, s31, -v195
    v_cvt_pk_bf16_f32 v154, v156, v157
    v_mfma_f32_16x16x32_bf16 v[132:135], a[84:87], a[4:7], v[132:135]
    s_add_u32 s25, s3, s4
    v_exp_f32 v159, v159
    v_mfma_f32_16x16x32_bf16 v[132:135], a[88:91], a[8:11], v[132:135]
    v_mfma_f32_16x16x32_bf16 v[132:135], a[92:95], a[12:15], v[132:135]
    s_waitcnt lgkmcnt(4)
    v_mfma_f32_16x16x32_bf16 v[136:139], a[96:99], a[0:3], 0
    v_fma_f32 v128, v128, s31, -v192
    v_cvt_pk_bf16_f32 v155, v158, v159
    v_mfma_f32_16x16x32_bf16 v[136:139], a[100:103], a[4:7], v[136:139]
    s_add_u32 s39, s27, 16384
    v_exp_f32 v128, v128
    v_mfma_f32_16x16x32_bf16 v[136:139], a[104:107], a[8:11], v[136:139]
    v_fma_f32 v129, v129, s31, -v192
    v_mfma_f32_16x16x32_bf16 v[136:139], a[108:111], a[12:15], v[136:139]
    s_waitcnt lgkmcnt(0)
    v_exp_f32 v129, v129
    v_mfma_f32_16x16x32_bf16 v[140:143], a[112:115], a[0:3], 0
    v_fma_f32 v130, v130, s31, -v192
    v_mfma_f32_16x16x32_bf16 v[140:143], a[116:119], a[4:7], v[140:143]
    s_cmp_eq_u32 s39, 49152
    s_cselect_b32 s39, 0, s39
    v_exp_f32 v130, v130
    v_mfma_f32_16x16x32_bf16 v[140:143], a[120:123], a[8:11], v[140:143]
    s_sub_u32 s28, s39, s27
    v_fma_f32 v131, v131, s31, -v192
    v_cvt_pk_bf16_f32 v128, v128, v129
    v_mfma_f32_16x16x32_bf16 v[140:143], a[124:127], a[12:15], v[140:143]
    v_exp_f32 v131, v131
    v_mfma_f32_16x16x32_bf16 v[96:99], a[128:131], v[144:147], v[96:99]
    v_fma_f32 v132, v132, s31, -v192
    v_cvt_pk_bf16_f32 v129, v130, v131
    v_mfma_f32_16x16x32_bf16 v[96:99], a[132:135], v[152:155], v[96:99]
    ds_read_b64_tr_b16 a[128:129], v168
    v_exp_f32 v132, v132
    v_mfma_f32_16x16x32_bf16 v[100:103], a[136:139], v[144:147], v[100:103]
    ds_read_b64_tr_b16 a[130:131], v168 offset:4096
    ds_read_b64_tr_b16 a[132:133], v168 offset:8192
    v_fma_f32 v133, v133, s31, -v192
    v_mfma_f32_16x16x32_bf16 v[100:103], a[140:143], v[152:155], v[100:103]
    v_exp_f32 v133, v133
    v_mfma_f32_16x16x32_bf16 v[104:107], a[144:147], v[144:147], v[104:107]
    s_add_u32 s29, s27, s50
    ds_read_b64_tr_b16 a[134:135], v168 offset:12288
    ds_read_b64_tr_b16 a[136:137], v168 offset:8
    v_fma_f32 v134, v134, s31, -v192
    v_mfma_f32_16x16x32_bf16 v[104:107], a[148:151], v[152:155], v[104:107]
    v_exp_f32 v134, v134
    v_cvt_pk_bf16_f32 v130, v132, v133
    v_mfma_f32_16x16x32_bf16 v[108:111], a[152:155], v[144:147], v[108:111]
    ds_read_b64_tr_b16 a[138:139], v168 offset:4104
    v_fma_f32 v135, v135, s31, -v192
    v_mfma_f32_16x16x32_bf16 v[108:111], a[156:159], v[152:155], v[108:111]
    ds_read_b64_tr_b16 a[140:141], v168 offset:8200
    v_exp_f32 v135, v135
    v_mfma_f32_16x16x32_bf16 v[112:115], a[160:163], v[144:147], v[112:115]
    ds_read_b64_tr_b16 a[142:143], v168 offset:12296
    v_fma_f32 v136, v136, s31, -v192
    v_mfma_f32_16x16x32_bf16 v[112:115], a[164:167], v[152:155], v[112:115]
    v_exp_f32 v136, v136
    v_cvt_pk_bf16_f32 v131, v134, v135
    v_mfma_f32_16x16x32_bf16 v[116:119], a[168:171], v[144:147], v[116:119]
    ds_read_b64_tr_b16 a[144:145], v169
    v_fma_f32 v137, v137, s31, -v192
    v_mfma_f32_16x16x32_bf16 v[116:119], a[172:175], v[152:155], v[116:119]
    v_exp_f32 v137, v137
    v_mfma_f32_16x16x32_bf16 v[120:123], a[176:179], v[144:147], v[120:123]
    ds_read_b64_tr_b16 a[146:147], v169 offset:4096
    v_fma_f32 v138, v138, s31, -v192
    v_cvt_pk_bf16_f32 v136, v136, v137
    v_mfma_f32_16x16x32_bf16 v[120:123], a[180:183], v[152:155], v[120:123]
    v_exp_f32 v138, v138
    v_mfma_f32_16x16x32_bf16 v[124:127], a[184:187], v[144:147], v[124:127]
    ds_read_b64_tr_b16 a[148:149], v169 offset:8192
    ds_read_b64_tr_b16 a[150:151], v169 offset:12288
    v_fma_f32 v139, v139, s31, -v192
    v_mfma_f32_16x16x32_bf16 v[124:127], a[188:191], v[152:155], v[124:127]
    v_exp_f32 v139, v139
    v_mfma_f32_16x16x32_bf16 a[204:207], a[208:211], v[144:147], a[204:207]
    v_fma_f32 v140, v140, s31, -v192
    v_cvt_pk_bf16_f32 v137, v138, v139
    v_mfma_f32_16x16x32_bf16 a[204:207], a[208:211], v[152:155], a[204:207]
    v_exp_f32 v140, v140
    v_mfma_f32_16x16x32_bf16 v[144:147], a[64:67], a[16:19], 0
    ds_read_b64_tr_b16 a[152:153], v169 offset:8
    ds_read_b64_tr_b16 a[154:155], v169 offset:4104
    v_fma_f32 v141, v141, s31, -v192
    v_mfma_f32_16x16x32_bf16 v[144:147], a[68:71], a[20:23], v[144:147]
    v_exp_f32 v141, v141
    v_mfma_f32_16x16x32_bf16 v[144:147], a[72:75], a[24:27], v[144:147]
    ds_read_b64_tr_b16 a[156:157], v169 offset:8200
    v_fma_f32 v142, v142, s31, -v192
    v_cvt_pk_bf16_f32 v138, v140, v141
    v_mfma_f32_16x16x32_bf16 v[144:147], a[76:79], a[28:31], v[144:147]
    ds_read_b64_tr_b16 a[158:159], v169 offset:12296
    v_exp_f32 v142, v142
    v_mfma_f32_16x16x32_bf16 v[148:151], a[80:83], a[16:19], 0
    ds_read_b64_tr_b16 a[160:161], v170
    ds_read_b64_tr_b16 a[162:163], v170 offset:4096
    v_fma_f32 v143, v143, s31, -v192
    v_mfma_f32_16x16x32_bf16 v[148:151], a[84:87], a[20:23], v[148:151]
    ds_read_b64_tr_b16 a[164:165], v170 offset:8192
    v_exp_f32 v143, v143
    v_mfma_f32_16x16x32_bf16 v[148:151], a[88:91], a[24:27], v[148:151]
    buffer_store_dwordx4 a[236:239], v186, s[20:23], s36 offen offset:2048 sc1 nt
    v_mfma_f32_16x16x32_bf16 v[148:151], a[92:95], a[28:31], v[148:151]
    ds_read_b64_tr_b16 a[166:167], v170 offset:12288
    ds_read_b64_tr_b16 a[168:169], v170 offset:8
    v_mfma_f32_16x16x32_bf16 v[152:155], a[96:99], a[16:19], 0
    v_fma_f32 v144, v144, s31, -v193
    v_cvt_pk_bf16_f32 v139, v142, v143
    v_mfma_f32_16x16x32_bf16 v[152:155], a[100:103], a[20:23], v[152:155]
    v_exp_f32 v144, v144
    v_mfma_f32_16x16x32_bf16 v[152:155], a[104:107], a[24:27], v[152:155]
    ds_read_b64_tr_b16 a[170:171], v170 offset:4104
    v_fma_f32 v145, v145, s31, -v193
    v_mfma_f32_16x16x32_bf16 v[152:155], a[108:111], a[28:31], v[152:155]
    ds_read_b64_tr_b16 a[172:173], v170 offset:8200
    v_exp_f32 v145, v145
    v_mfma_f32_16x16x32_bf16 v[156:159], a[112:115], a[16:19], 0
    ds_read_b64_tr_b16 a[174:175], v170 offset:12296
    ds_read_b64_tr_b16 a[176:177], v171
    v_fma_f32 v146, v146, s31, -v193
    v_cvt_pk_bf16_f32 v144, v144, v145
    v_mfma_f32_16x16x32_bf16 v[156:159], a[116:119], a[20:23], v[156:159]
    v_exp_f32 v146, v146
    v_mfma_f32_16x16x32_bf16 v[156:159], a[120:123], a[24:27], v[156:159]
    ds_read_b64_tr_b16 a[178:179], v171 offset:4096
    ds_read_b64_tr_b16 a[180:181], v171 offset:8192
    v_fma_f32 v147, v147, s31, -v193
    v_mfma_f32_16x16x32_bf16 v[156:159], a[124:127], a[28:31], v[156:159]
    s_waitcnt lgkmcnt(15)
    v_exp_f32 v147, v147
    v_mfma_f32_16x16x32_bf16 v[0:3], a[128:131], v[128:131], v[0:3]
    v_fma_f32 v148, v148, s31, -v193
    v_cvt_pk_bf16_f32 v145, v146, v147
    v_mfma_f32_16x16x32_bf16 v[0:3], a[132:135], v[136:139], v[0:3]
    ds_read_b64_tr_b16 a[182:183], v171 offset:12288
    v_exp_f32 v148, v148
    v_mfma_f32_16x16x32_bf16 v[4:7], a[136:139], v[128:131], v[4:7]
    ds_read_b64_tr_b16 a[184:185], v171 offset:8
    v_fma_f32 v149, v149, s31, -v193
    v_mfma_f32_16x16x32_bf16 v[4:7], a[140:143], v[136:139], v[4:7]
    v_exp_f32 v149, v149
    v_mfma_f32_16x16x32_bf16 v[8:11], a[144:147], v[128:131], v[8:11]
    ds_read_b64_tr_b16 a[186:187], v171 offset:4104
    v_fma_f32 v150, v150, s31, -v193
    v_mfma_f32_16x16x32_bf16 v[8:11], a[148:151], v[136:139], v[8:11]
    s_waitcnt lgkmcnt(14)
    v_exp_f32 v150, v150
    v_mfma_f32_16x16x32_bf16 v[12:15], a[152:155], v[128:131], v[12:15]
    v_fma_f32 v151, v151, s31, -v193
    v_cvt_pk_bf16_f32 v146, v148, v149
    v_mfma_f32_16x16x32_bf16 v[12:15], a[156:159], v[136:139], v[12:15]
    s_waitcnt lgkmcnt(10)
    v_exp_f32 v151, v151
    v_mfma_f32_16x16x32_bf16 v[16:19], a[160:163], v[128:131], v[16:19]
    ds_read_b64_tr_b16 a[188:189], v171 offset:8200
    ds_read_b64_tr_b16 a[190:191], v171 offset:12296
    v_fma_f32 v152, v152, s31, -v193
    v_mfma_f32_16x16x32_bf16 v[16:19], a[164:167], v[136:139], v[16:19]
    s_waitcnt lgkmcnt(8)
    v_exp_f32 v152, v152
    v_mfma_f32_16x16x32_bf16 v[20:23], a[168:171], v[128:131], v[20:23]
    v_fma_f32 v153, v153, s31, -v193
    v_cvt_pk_bf16_f32 v147, v150, v151
    v_mfma_f32_16x16x32_bf16 v[20:23], a[172:175], v[136:139], v[20:23]
    s_waitcnt lgkmcnt(4)
    v_exp_f32 v153, v153
    v_mfma_f32_16x16x32_bf16 v[24:27], a[176:179], v[128:131], v[24:27]
    v_fma_f32 v154, v154, s31, -v193
    v_cvt_pk_bf16_f32 v152, v152, v153
    v_mfma_f32_16x16x32_bf16 v[24:27], a[180:183], v[136:139], v[24:27]
    s_waitcnt lgkmcnt(0)
    v_exp_f32 v154, v154
    v_mfma_f32_16x16x32_bf16 v[28:31], a[184:187], v[128:131], v[28:31]
    v_fma_f32 v155, v155, s31, -v193
    v_add_u32 v160, s28, v160
    v_mfma_f32_16x16x32_bf16 v[28:31], a[188:191], v[136:139], v[28:31]
    v_exp_f32 v155, v155
    v_mfma_f32_16x16x32_bf16 a[192:195], a[208:211], v[128:131], a[192:195]
    v_fma_f32 v156, v156, s31, -v193
    v_add_u32 v171, s28, v171
    v_mfma_f32_16x16x32_bf16 a[192:195], a[208:211], v[136:139], a[192:195]
    v_exp_f32 v156, v156
    v_mfma_f32_16x16x32_bf16 v[128:131], a[64:67], a[32:35], 0
    v_fma_f32 v157, v157, s31, -v193
    v_cvt_pk_bf16_f32 v153, v154, v155
    v_mfma_f32_16x16x32_bf16 v[128:131], a[68:71], a[36:39], v[128:131]
    v_exp_f32 v157, v157
    v_mfma_f32_16x16x32_bf16 v[128:131], a[72:75], a[40:43], v[128:131]
    v_fma_f32 v158, v158, s31, -v193
    v_add_u32 v169, s28, v169
    v_mfma_f32_16x16x32_bf16 v[128:131], a[76:79], a[44:47], v[128:131]
    v_exp_f32 v158, v158
    v_mfma_f32_16x16x32_bf16 v[132:135], a[80:83], a[32:35], 0
    v_fma_f32 v159, v159, s31, -v193
    v_cvt_pk_bf16_f32 v154, v156, v157
    v_mfma_f32_16x16x32_bf16 v[132:135], a[84:87], a[36:39], v[132:135]
    s_add_u32 m0, s34, 4096
    v_exp_f32 v159, v159
    v_mfma_f32_16x16x32_bf16 v[132:135], a[88:91], a[40:43], v[132:135]
    buffer_load_dwordx4 v186, s[16:19], s36 offen offset:2048 nt lds
    v_mfma_f32_16x16x32_bf16 v[132:135], a[92:95], a[44:47], v[132:135]
    buffer_store_dwordx4 a[240:243], v187, s[20:23], s36 offen offset:3072 sc1 nt
    v_mfma_f32_16x16x32_bf16 v[136:139], a[96:99], a[32:35], 0
    v_fma_f32 v128, v128, s31, -v194
    v_cvt_pk_bf16_f32 v155, v158, v159
    v_mfma_f32_16x16x32_bf16 v[136:139], a[100:103], a[36:39], v[136:139]
    v_exp_f32 v128, v128
    v_mfma_f32_16x16x32_bf16 v[136:139], a[104:107], a[40:43], v[136:139]
    v_fma_f32 v129, v129, s31, -v194
    v_add_u32 v168, s28, v168
    v_mfma_f32_16x16x32_bf16 v[136:139], a[108:111], a[44:47], v[136:139]
    v_exp_f32 v129, v129
    v_mfma_f32_16x16x32_bf16 v[140:143], a[112:115], a[32:35], 0
    v_fma_f32 v130, v130, s31, -v194
    v_add_u32 v170, s28, v170
    v_mfma_f32_16x16x32_bf16 v[140:143], a[116:119], a[36:39], v[140:143]
    v_exp_f32 v130, v130
    v_mfma_f32_16x16x32_bf16 v[140:143], a[120:123], a[40:43], v[140:143]
    v_fma_f32 v131, v131, s31, -v194
    v_cvt_pk_bf16_f32 v128, v128, v129
    v_mfma_f32_16x16x32_bf16 v[140:143], a[124:127], a[44:47], v[140:143]
    v_exp_f32 v131, v131
    v_mfma_f32_16x16x32_bf16 v[32:35], a[128:131], v[144:147], v[32:35]
    v_fma_f32 v132, v132, s31, -v194
    v_cvt_pk_bf16_f32 v129, v130, v131
    v_mfma_f32_16x16x32_bf16 v[32:35], a[132:135], v[152:155], v[32:35]
    v_exp_f32 v132, v132
    v_mfma_f32_16x16x32_bf16 v[36:39], a[136:139], v[144:147], v[36:39]
    v_fma_f32 v133, v133, s31, -v194
    v_add_u32 v161, s28, v161
    v_mfma_f32_16x16x32_bf16 v[36:39], a[140:143], v[152:155], v[36:39]
    v_exp_f32 v133, v133
    v_mfma_f32_16x16x32_bf16 v[40:43], a[144:147], v[144:147], v[40:43]
    v_fma_f32 v134, v134, s31, -v194
    v_cvt_pk_bf16_f32 v130, v132, v133
    v_mfma_f32_16x16x32_bf16 v[40:43], a[148:151], v[152:155], v[40:43]
    v_exp_f32 v134, v134
    v_mfma_f32_16x16x32_bf16 v[44:47], a[152:155], v[144:147], v[44:47]
    v_fma_f32 v135, v135, s31, -v194
    v_add_u32 v162, s28, v162
    v_mfma_f32_16x16x32_bf16 v[44:47], a[156:159], v[152:155], v[44:47]
    v_exp_f32 v135, v135
    v_mfma_f32_16x16x32_bf16 v[48:51], a[160:163], v[144:147], v[48:51]
    v_fma_f32 v136, v136, s31, -v194
    v_add_u32 v163, s28, v163
    v_mfma_f32_16x16x32_bf16 v[48:51], a[164:167], v[152:155], v[48:51]
    v_exp_f32 v136, v136
    v_mfma_f32_16x16x32_bf16 v[52:55], a[168:171], v[144:147], v[52:55]
    v_fma_f32 v137, v137, s31, -v194
    v_cvt_pk_bf16_f32 v131, v134, v135
    v_mfma_f32_16x16x32_bf16 v[52:55], a[172:175], v[152:155], v[52:55]
    s_add_u32 m0, s34, 4096
    v_exp_f32 v137, v137
    v_mfma_f32_16x16x32_bf16 v[56:59], a[176:179], v[144:147], v[56:59]
    buffer_load_dwordx4 v187, s[16:19], s36 offen offset:3072 nt lds
    v_fma_f32 v138, v138, s31, -v194
    v_mfma_f32_16x16x32_bf16 v[56:59], a[180:183], v[152:155], v[56:59]
    v_exp_f32 v138, v138
    v_mfma_f32_16x16x32_bf16 v[60:63], a[184:187], v[144:147], v[60:63]
    v_fma_f32 v139, v139, s31, -v194
    v_cvt_pk_bf16_f32 v136, v136, v137
    v_mfma_f32_16x16x32_bf16 v[60:63], a[188:191], v[152:155], v[60:63]
    v_exp_f32 v139, v139
    v_mfma_f32_16x16x32_bf16 a[196:199], a[208:211], v[144:147], a[196:199]
    s_add_u32 s27, s27, s28
    v_fma_f32 v140, v140, s31, -v194
    v_cvt_pk_bf16_f32 v137, v138, v139
    v_mfma_f32_16x16x32_bf16 a[196:199], a[208:211], v[152:155], a[196:199]
    v_exp_f32 v140, v140
    v_mfma_f32_16x16x32_bf16 v[144:147], a[64:67], a[48:51], 0
    v_fma_f32 v141, v141, s31, -v194
    s_waitcnt vmcnt(16)
    s_barrier
    v_mfma_f32_16x16x32_bf16 v[144:147], a[68:71], a[52:55], v[144:147]
    ds_read_b128 a[64:67], v160
    v_exp_f32 v141, v141
    v_mfma_f32_16x16x32_bf16 v[144:147], a[72:75], a[56:59], v[144:147]
    ds_read_b128 a[68:71], v161
    v_fma_f32 v142, v142, s31, -v194
    v_mfma_f32_16x16x32_bf16 v[144:147], a[76:79], a[60:63], v[144:147]
    ds_read_b128 a[72:75], v162
    v_exp_f32 v142, v142
    v_mfma_f32_16x16x32_bf16 v[148:151], a[80:83], a[48:51], 0
    v_fma_f32 v143, v143, s31, -v194
    v_cvt_pk_bf16_f32 v138, v140, v141
    v_mfma_f32_16x16x32_bf16 v[148:151], a[84:87], a[52:55], v[148:151]
    s_mov_b32 m0, s29
    v_exp_f32 v143, v143
    v_mfma_f32_16x16x32_bf16 v[148:151], a[88:91], a[56:59], v[148:151]
    buffer_load_dwordx4 v184, s[8:11], s25 offen nt lds
    v_mfma_f32_16x16x32_bf16 v[148:151], a[92:95], a[60:63], v[148:151]
    ds_read_b128 a[76:79], v163
    buffer_load_dwordx4 v185, s[8:11], s25 offen offset:1024 nt lds
    v_cvt_pk_bf16_f32 v139, v142, v143
    v_mfma_f32_16x16x32_bf16 v[152:155], a[96:99], a[48:51], 0
    buffer_load_dwordx4 v186, s[8:11], s25 offen offset:2048 nt lds
    v_fma_f32 v144, v144, s31, -v195
    v_mfma_f32_16x16x32_bf16 v[152:155], a[100:103], a[52:55], v[152:155]
    v_exp_f32 v144, v144
    v_mfma_f32_16x16x32_bf16 v[152:155], a[104:107], a[56:59], v[152:155]
    buffer_load_dwordx4 v187, s[8:11], s25 offen offset:3072 nt lds
    v_fma_f32 v145, v145, s31, -v195
    v_mfma_f32_16x16x32_bf16 v[152:155], a[108:111], a[60:63], v[152:155]
    v_exp_f32 v145, v145
    v_mfma_f32_16x16x32_bf16 v[156:159], a[112:115], a[48:51], 0
    ds_read_b128 a[80:83], v160 offset:4096
    v_fma_f32 v146, v146, s31, -v195
    v_mfma_f32_16x16x32_bf16 v[156:159], a[116:119], a[52:55], v[156:159]
    s_add_u32 m0, s29, 49152
    v_exp_f32 v146, v146
    v_cvt_pk_bf16_f32 v144, v144, v145
    v_mfma_f32_16x16x32_bf16 v[156:159], a[120:123], a[56:59], v[156:159]
    buffer_load_dwordx4 v188, s[12:15], s25 offen nt lds
    v_fma_f32 v147, v147, s31, -v195
    v_mfma_f32_16x16x32_bf16 v[156:159], a[124:127], a[60:63], v[156:159]
    v_exp_f32 v147, v147
    v_mfma_f32_16x16x32_bf16 v[64:67], a[128:131], v[128:131], v[64:67]
    buffer_load_dwordx4 v188, s[12:15], s25 offen offset:1024 nt lds
    v_fma_f32 v148, v148, s31, -v195
    v_mfma_f32_16x16x32_bf16 v[64:67], a[132:135], v[136:139], v[64:67]
    v_exp_f32 v148, v148
    v_cvt_pk_bf16_f32 v145, v146, v147
    v_mfma_f32_16x16x32_bf16 v[68:71], a[136:139], v[128:131], v[68:71]
    ds_read_b128 a[84:87], v161 offset:4096
    ds_read_b128 a[88:91], v162 offset:4096
    v_fma_f32 v149, v149, s31, -v195
    v_mfma_f32_16x16x32_bf16 v[68:71], a[140:143], v[136:139], v[68:71]
    v_exp_f32 v149, v149
    v_mfma_f32_16x16x32_bf16 v[72:75], a[144:147], v[128:131], v[72:75]
    ds_read_b128 a[92:95], v163 offset:4096
    v_fma_f32 v150, v150, s31, -v195
    v_cvt_pk_bf16_f32 v146, v148, v149
    v_mfma_f32_16x16x32_bf16 v[72:75], a[148:151], v[136:139], v[72:75]
    ds_read_b128 a[96:99], v160 offset:8192
    v_exp_f32 v150, v150
    v_mfma_f32_16x16x32_bf16 v[76:79], a[152:155], v[128:131], v[76:79]
    ds_read_b128 a[100:103], v161 offset:8192
    v_fma_f32 v151, v151, s31, -v195
    v_mfma_f32_16x16x32_bf16 v[76:79], a[156:159], v[136:139], v[76:79]
    buffer_load_dwordx4 v188, s[12:15], s25 offen offset:2048 nt lds
    v_exp_f32 v151, v151
    v_mfma_f32_16x16x32_bf16 v[80:83], a[160:163], v[128:131], v[80:83]
    buffer_load_dwordx4 v188, s[12:15], s25 offen offset:3072 nt lds
    v_fma_f32 v152, v152, s31, -v195
    v_mfma_f32_16x16x32_bf16 v[80:83], a[164:167], v[136:139], v[80:83]
    v_exp_f32 v152, v152
    v_mfma_f32_16x16x32_bf16 v[84:87], a[168:171], v[128:131], v[84:87]
    v_fma_f32 v153, v153, s31, -v195
    v_cvt_pk_bf16_f32 v147, v150, v151
    v_mfma_f32_16x16x32_bf16 v[84:87], a[172:175], v[136:139], v[84:87]
    ds_read_b128 a[104:107], v162 offset:8192
    v_exp_f32 v153, v153
    v_mfma_f32_16x16x32_bf16 v[88:91], a[176:179], v[128:131], v[88:91]
    v_fma_f32 v154, v154, s31, -v195
    v_cvt_pk_bf16_f32 v152, v152, v153
    v_mfma_f32_16x16x32_bf16 v[88:91], a[180:183], v[136:139], v[88:91]
    v_exp_f32 v154, v154
    v_mfma_f32_16x16x32_bf16 v[92:95], a[184:187], v[128:131], v[92:95]
    ds_read_b128 a[108:111], v163 offset:8192
    ds_read_b128 a[112:115], v160 offset:12288
    v_fma_f32 v155, v155, s31, -v195
    v_mfma_f32_16x16x32_bf16 v[92:95], a[188:191], v[136:139], v[92:95]
    ds_read_b128 a[116:119], v161 offset:12288
    v_exp_f32 v155, v155
    v_mfma_f32_16x16x32_bf16 a[200:203], a[208:211], v[128:131], a[200:203]
    ds_read_b128 a[120:123], v162 offset:12288
    ds_read_b128 a[124:127], v163 offset:12288
    v_fma_f32 v156, v156, s31, -v195
    v_mfma_f32_16x16x32_bf16 a[200:203], a[208:211], v[136:139], a[200:203]
    s_waitcnt lgkmcnt(12)
    v_exp_f32 v156, v156
    v_mfma_f32_16x16x32_bf16 v[128:131], a[64:67], a[0:3], 0
    v_fma_f32 v157, v157, s31, -v195
    v_cvt_pk_bf16_f32 v153, v154, v155
    v_mfma_f32_16x16x32_bf16 v[128:131], a[68:71], a[4:7], v[128:131]
    s_add_u32 s4, s4, 16384
    v_exp_f32 v157, v157
    v_mfma_f32_16x16x32_bf16 v[128:131], a[72:75], a[8:11], v[128:131]
    s_and_b32 s4, s4, 0x1ffff
    v_fma_f32 v158, v158, s31, -v195
    v_cvt_pk_bf16_f32 v154, v156, v157
    v_mfma_f32_16x16x32_bf16 v[128:131], a[76:79], a[12:15], v[128:131]
    s_waitcnt lgkmcnt(8)
    v_exp_f32 v158, v158
    v_mfma_f32_16x16x32_bf16 v[132:135], a[80:83], a[0:3], 0
    v_fma_f32 v159, v159, s31, -v195
    v_mfma_f32_16x16x32_bf16 v[132:135], a[84:87], a[4:7], v[132:135]
    s_add_u32 s25, s3, s4
    v_exp_f32 v159, v159
    v_mfma_f32_16x16x32_bf16 v[132:135], a[88:91], a[8:11], v[132:135]
    v_mfma_f32_16x16x32_bf16 v[132:135], a[92:95], a[12:15], v[132:135]
    s_waitcnt lgkmcnt(4)
    v_cvt_pk_bf16_f32 v155, v158, v159
    v_mfma_f32_16x16x32_bf16 v[136:139], a[96:99], a[0:3], 0
    v_fma_f32 v128, v128, s31, -v192
    v_mfma_f32_16x16x32_bf16 v[136:139], a[100:103], a[4:7], v[136:139]
    s_add_u32 s39, s27, 16384
    v_exp_f32 v128, v128
    v_mfma_f32_16x16x32_bf16 v[136:139], a[104:107], a[8:11], v[136:139]
    v_fma_f32 v129, v129, s31, -v192
    v_mfma_f32_16x16x32_bf16 v[136:139], a[108:111], a[12:15], v[136:139]
    s_waitcnt lgkmcnt(0)
    v_exp_f32 v129, v129
    v_mfma_f32_16x16x32_bf16 v[140:143], a[112:115], a[0:3], 0
    v_fma_f32 v130, v130, s31, -v192
    v_mfma_f32_16x16x32_bf16 v[140:143], a[116:119], a[4:7], v[140:143]
    s_cmp_eq_u32 s39, 49152
    s_cselect_b32 s39, 0, s39
    v_exp_f32 v130, v130
    v_mfma_f32_16x16x32_bf16 v[140:143], a[120:123], a[8:11], v[140:143]
    s_sub_u32 s28, s39, s27
    v_fma_f32 v131, v131, s31, -v192
    v_cvt_pk_bf16_f32 v128, v128, v129
    v_mfma_f32_16x16x32_bf16 v[140:143], a[124:127], a[12:15], v[140:143]
    v_exp_f32 v131, v131
    v_mfma_f32_16x16x32_bf16 v[96:99], a[128:131], v[144:147], v[96:99]
    v_fma_f32 v132, v132, s31, -v192
    v_cvt_pk_bf16_f32 v129, v130, v131
    v_mfma_f32_16x16x32_bf16 v[96:99], a[132:135], v[152:155], v[96:99]
    v_exp_f32 v132, v132
    v_mfma_f32_16x16x32_bf16 v[100:103], a[136:139], v[144:147], v[100:103]
    ds_read_b64_tr_b16 a[128:129], v168
    ds_read_b64_tr_b16 a[130:131], v168 offset:4096
    v_fma_f32 v133, v133, s31, -v192
    v_mfma_f32_16x16x32_bf16 v[100:103], a[140:143], v[152:155], v[100:103]
    ds_read_b64_tr_b16 a[132:133], v168 offset:8192
    v_exp_f32 v133, v133
    v_mfma_f32_16x16x32_bf16 v[104:107], a[144:147], v[144:147], v[104:107]
    s_add_u32 s29, s27, s50
    ds_read_b64_tr_b16 a[134:135], v168 offset:12288
    v_fma_f32 v134, v134, s31, -v192
    v_cvt_pk_bf16_f32 v130, v132, v133
    v_mfma_f32_16x16x32_bf16 v[104:107], a[148:151], v[152:155], v[104:107]
    v_exp_f32 v134, v134
    v_mfma_f32_16x16x32_bf16 v[108:111], a[152:155], v[144:147], v[108:111]
    buffer_store_dwordx4 a[212:215], v184, s[20:23], s37 offen sc1 nt
    v_fma_f32 v135, v135, s31, -v192
    v_mfma_f32_16x16x32_bf16 v[108:111], a[156:159], v[152:155], v[108:111]
    v_exp_f32 v135, v135
    v_mfma_f32_16x16x32_bf16 v[112:115], a[160:163], v[144:147], v[112:115]
    ds_read_b64_tr_b16 a[136:137], v168 offset:8
    v_fma_f32 v136, v136, s31, -v192
    v_mfma_f32_16x16x32_bf16 v[112:115], a[164:167], v[152:155], v[112:115]
    v_exp_f32 v136, v136
    v_mfma_f32_16x16x32_bf16 v[116:119], a[168:171], v[144:147], v[116:119]
    ds_read_b64_tr_b16 a[138:139], v168 offset:4104
    ds_read_b64_tr_b16 a[140:141], v168 offset:8200
    v_fma_f32 v137, v137, s31, -v192
    v_mfma_f32_16x16x32_bf16 v[116:119], a[172:175], v[152:155], v[116:119]
    v_exp_f32 v137, v137
    v_cvt_pk_bf16_f32 v131, v134, v135
    v_mfma_f32_16x16x32_bf16 v[120:123], a[176:179], v[144:147], v[120:123]
    ds_read_b64_tr_b16 a[142:143], v168 offset:12296
    v_fma_f32 v138, v138, s31, -v192
    v_mfma_f32_16x16x32_bf16 v[120:123], a[180:183], v[152:155], v[120:123]
    ds_read_b64_tr_b16 a[144:145], v169
    v_exp_f32 v138, v138
    v_mfma_f32_16x16x32_bf16 v[124:127], a[184:187], v[144:147], v[124:127]
    v_fma_f32 v139, v139, s31, -v192
    v_cvt_pk_bf16_f32 v136, v136, v137
    v_mfma_f32_16x16x32_bf16 v[124:127], a[188:191], v[152:155], v[124:127]
    v_exp_f32 v139, v139
    v_mfma_f32_16x16x32_bf16 a[204:207], a[208:211], v[144:147], a[204:207]
    v_fma_f32 v140, v140, s31, -v192
    v_cvt_pk_bf16_f32 v137, v138, v139
    v_mfma_f32_16x16x32_bf16 a[204:207], a[208:211], v[152:155], a[204:207]
    ds_read_b64_tr_b16 a[146:147], v169 offset:4096
    v_exp_f32 v140, v140
    v_mfma_f32_16x16x32_bf16 v[144:147], a[64:67], a[16:19], 0
    ds_read_b64_tr_b16 a[148:149], v169 offset:8192
    v_fma_f32 v141, v141, s31, -v192
    v_mfma_f32_16x16x32_bf16 v[144:147], a[68:71], a[20:23], v[144:147]
    v_exp_f32 v141, v141
    v_mfma_f32_16x16x32_bf16 v[144:147], a[72:75], a[24:27], v[144:147]
    ds_read_b64_tr_b16 a[150:151], v169 offset:12288
    v_fma_f32 v142, v142, s31, -v192
    v_cvt_pk_bf16_f32 v138, v140, v141
    v_mfma_f32_16x16x32_bf16 v[144:147], a[76:79], a[28:31], v[144:147]
    v_exp_f32 v142, v142
    v_mfma_f32_16x16x32_bf16 v[148:151], a[80:83], a[16:19], 0
    ds_read_b64_tr_b16 a[152:153], v169 offset:8
    ds_read_b64_tr_b16 a[154:155], v169 offset:4104
    v_fma_f32 v143, v143, s31, -v192
    v_mfma_f32_16x16x32_bf16 v[148:151], a[84:87], a[20:23], v[148:151]
    ds_read_b64_tr_b16 a[156:157], v169 offset:8200
    v_exp_f32 v143, v143
    v_mfma_f32_16x16x32_bf16 v[148:151], a[88:91], a[24:27], v[148:151]
    ds_read_b64_tr_b16 a[158:159], v169 offset:12296
    v_cvt_pk_bf16_f32 v139, v142, v143
    v_mfma_f32_16x16x32_bf16 v[148:151], a[92:95], a[28:31], v[148:151]
    ds_read_b64_tr_b16 a[160:161], v170
    ds_read_b64_tr_b16 a[162:163], v170 offset:4096
    v_mfma_f32_16x16x32_bf16 v[152:155], a[96:99], a[16:19], 0
    ds_read_b64_tr_b16 a[164:165], v170 offset:8192
    ds_read_b64_tr_b16 a[166:167], v170 offset:12288
    v_fma_f32 v144, v144, s31, -v193
    v_mfma_f32_16x16x32_bf16 v[152:155], a[100:103], a[20:23], v[152:155]
    v_exp_f32 v144, v144
    v_mfma_f32_16x16x32_bf16 v[152:155], a[104:107], a[24:27], v[152:155]
    ds_read_b64_tr_b16 a[168:169], v170 offset:8
    ds_read_b64_tr_b16 a[170:171], v170 offset:4104
    v_fma_f32 v145, v145, s31, -v193
    v_mfma_f32_16x16x32_bf16 v[152:155], a[108:111], a[28:31], v[152:155]
    v_exp_f32 v145, v145
    v_mfma_f32_16x16x32_bf16 v[156:159], a[112:115], a[16:19], 0
    ds_read_b64_tr_b16 a[172:173], v170 offset:8200
    v_fma_f32 v146, v146, s31, -v193
    v_mfma_f32_16x16x32_bf16 v[156:159], a[116:119], a[20:23], v[156:159]
    v_exp_f32 v146, v146
    v_mfma_f32_16x16x32_bf16 v[156:159], a[120:123], a[24:27], v[156:159]
    ds_read_b64_tr_b16 a[174:175], v170 offset:12296
    v_fma_f32 v147, v147, s31, -v193
    v_cvt_pk_bf16_f32 v144, v144, v145
    v_mfma_f32_16x16x32_bf16 v[156:159], a[124:127], a[28:31], v[156:159]
    s_waitcnt lgkmcnt(15)
    v_exp_f32 v147, v147
    v_mfma_f32_16x16x32_bf16 v[0:3], a[128:131], v[128:131], v[0:3]
    v_fma_f32 v148, v148, s31, -v193
    v_cvt_pk_bf16_f32 v145, v146, v147
    v_mfma_f32_16x16x32_bf16 v[0:3], a[132:135], v[136:139], v[0:3]
    ds_read_b64_tr_b16 a[176:177], v171
    v_exp_f32 v148, v148
    v_mfma_f32_16x16x32_bf16 v[4:7], a[136:139], v[128:131], v[4:7]
    ds_read_b64_tr_b16 a[178:179], v171 offset:4096
    ds_read_b64_tr_b16 a[180:181], v171 offset:8192
    v_fma_f32 v149, v149, s31, -v193
    v_mfma_f32_16x16x32_bf16 v[4:7], a[140:143], v[136:139], v[4:7]
    s_waitcnt lgkmcnt(15)
    v_exp_f32 v149, v149
    v_mfma_f32_16x16x32_bf16 v[8:11], a[144:147], v[128:131], v[8:11]
    ds_read_b64_tr_b16 a[182:183], v171 offset:12288
    v_fma_f32 v150, v150, s31, -v193
    v_mfma_f32_16x16x32_bf16 v[8:11], a[148:151], v[136:139], v[8:11]
    s_waitcnt lgkmcnt(12)
    v_exp_f32 v150, v150
    v_mfma_f32_16x16x32_bf16 v[12:15], a[152:155], v[128:131], v[12:15]
    v_fma_f32 v151, v151, s31, -v193
    v_cvt_pk_bf16_f32 v146, v148, v149
    v_mfma_f32_16x16x32_bf16 v[12:15], a[156:159], v[136:139], v[12:15]
    s_waitcnt lgkmcnt(8)
    ds_read_b64_tr_b16 a[184:185], v171 offset:8
    v_exp_f32 v151, v151
    v_mfma_f32_16x16x32_bf16 v[16:19], a[160:163], v[128:131], v[16:19]
    ds_read_b64_tr_b16 a[186:187], v171 offset:4104
    v_fma_f32 v152, v152, s31, -v193
    v_mfma_f32_16x16x32_bf16 v[16:19], a[164:167], v[136:139], v[16:19]
    s_waitcnt lgkmcnt(6)
    ds_read_b64_tr_b16 a[188:189], v171 offset:8200
    ds_read_b64_tr_b16 a[190:191], v171 offset:12296
    v_exp_f32 v152, v152
    v_mfma_f32_16x16x32_bf16 v[20:23], a[168:171], v[128:131], v[20:23]
    ds_read_b128 a[228:231], v190 offset:12288
    v_fma_f32 v153, v153, s31, -v193
    v_mfma_f32_16x16x32_bf16 v[20:23], a[172:175], v[136:139], v[20:23]
    s_waitcnt lgkmcnt(5)
    v_exp_f32 v153, v153
    v_cvt_pk_bf16_f32 v147, v150, v151
    v_mfma_f32_16x16x32_bf16 v[24:27], a[176:179], v[128:131], v[24:27]
    v_fma_f32 v154, v154, s31, -v193
    v_cvt_pk_bf16_f32 v152, v152, v153
    v_mfma_f32_16x16x32_bf16 v[24:27], a[180:183], v[136:139], v[24:27]
    s_waitcnt lgkmcnt(1)
    v_exp_f32 v154, v154
    v_mfma_f32_16x16x32_bf16 v[28:31], a[184:187], v[128:131], v[28:31]
    ds_read_b128 a[232:235], v190 offset:13312
    v_fma_f32 v155, v155, s31, -v193
    v_mfma_f32_16x16x32_bf16 v[28:31], a[188:191], v[136:139], v[28:31]
    v_exp_f32 v155, v155
    v_mfma_f32_16x16x32_bf16 a[192:195], a[208:211], v[128:131], a[192:195]
    ds_read_b128 a[236:239], v190 offset:14336
    v_fma_f32 v156, v156, s31, -v193
    v_mfma_f32_16x16x32_bf16 a[192:195], a[208:211], v[136:139], a[192:195]
    v_exp_f32 v156, v156
    v_mfma_f32_16x16x32_bf16 v[128:131], a[64:67], a[32:35], 0
    v_fma_f32 v157, v157, s31, -v193
    v_cvt_pk_bf16_f32 v153, v154, v155
    v_mfma_f32_16x16x32_bf16 v[128:131], a[68:71], a[36:39], v[128:131]
    v_exp_f32 v157, v157
    v_mfma_f32_16x16x32_bf16 v[128:131], a[72:75], a[40:43], v[128:131]
    v_fma_f32 v158, v158, s31, -v193
    v_cvt_pk_bf16_f32 v154, v156, v157
    v_mfma_f32_16x16x32_bf16 v[128:131], a[76:79], a[44:47], v[128:131]
    v_exp_f32 v158, v158
    v_mfma_f32_16x16x32_bf16 v[132:135], a[80:83], a[32:35], 0
    ds_read_b128 a[240:243], v190 offset:15360
    v_fma_f32 v159, v159, s31, -v193
    v_mfma_f32_16x16x32_bf16 v[132:135], a[84:87], a[36:39], v[132:135]
    v_exp_f32 v159, v159
    v_mfma_f32_16x16x32_bf16 v[132:135], a[88:91], a[40:43], v[132:135]
    s_add_u32 m0, s34, 8192
    v_cvt_pk_bf16_f32 v155, v158, v159
    v_add_u32 v161, s28, v161
    v_mfma_f32_16x16x32_bf16 v[132:135], a[92:95], a[44:47], v[132:135]
    buffer_load_dwordx4 v184, s[16:19], s37 offen nt lds
    v_mfma_f32_16x16x32_bf16 v[136:139], a[96:99], a[32:35], 0
    buffer_store_dwordx4 a[216:219], v185, s[20:23], s37 offen offset:1024 sc1 nt
    v_fma_f32 v128, v128, s31, -v194
    v_mfma_f32_16x16x32_bf16 v[136:139], a[100:103], a[36:39], v[136:139]
    v_exp_f32 v128, v128
    v_mfma_f32_16x16x32_bf16 v[136:139], a[104:107], a[40:43], v[136:139]
    v_fma_f32 v129, v129, s31, -v194
    v_add_u32 v162, s28, v162
    v_mfma_f32_16x16x32_bf16 v[136:139], a[108:111], a[44:47], v[136:139]
    v_exp_f32 v129, v129
    v_add_u32 v163, s28, v163
    v_mfma_f32_16x16x32_bf16 v[140:143], a[112:115], a[32:35], 0
    v_fma_f32 v130, v130, s31, -v194
    v_cvt_pk_bf16_f32 v128, v128, v129
    v_mfma_f32_16x16x32_bf16 v[140:143], a[116:119], a[36:39], v[140:143]
    v_exp_f32 v130, v130
    v_mfma_f32_16x16x32_bf16 v[140:143], a[120:123], a[40:43], v[140:143]
    v_fma_f32 v131, v131, s31, -v194
    v_add_u32 v168, s28, v168
    v_mfma_f32_16x16x32_bf16 v[140:143], a[124:127], a[44:47], v[140:143]
    s_add_u32 m0, s34, 8192
    v_exp_f32 v131, v131
    v_mfma_f32_16x16x32_bf16 v[32:35], a[128:131], v[144:147], v[32:35]
    buffer_load_dwordx4 v185, s[16:19], s37 offen offset:1024 nt lds
    v_fma_f32 v132, v132, s31, -v194
    v_mfma_f32_16x16x32_bf16 v[32:35], a[132:135], v[152:155], v[32:35]
    v_exp_f32 v132, v132
    v_mfma_f32_16x16x32_bf16 v[36:39], a[136:139], v[144:147], v[36:39]
    v_fma_f32 v133, v133, s31, -v194
    v_cvt_pk_bf16_f32 v129, v130, v131
    v_mfma_f32_16x16x32_bf16 v[36:39], a[140:143], v[152:155], v[36:39]
    v_exp_f32 v133, v133
    v_mfma_f32_16x16x32_bf16 v[40:43], a[144:147], v[144:147], v[40:43]
    v_fma_f32 v134, v134, s31, -v194
    v_cvt_pk_bf16_f32 v130, v132, v133
    v_mfma_f32_16x16x32_bf16 v[40:43], a[148:151], v[152:155], v[40:43]
    v_exp_f32 v134, v134
    v_mfma_f32_16x16x32_bf16 v[44:47], a[152:155], v[144:147], v[44:47]
    v_fma_f32 v135, v135, s31, -v194
    v_add_u32 v170, s28, v170
    v_mfma_f32_16x16x32_bf16 v[44:47], a[156:159], v[152:155], v[44:47]
    v_exp_f32 v135, v135
    v_mfma_f32_16x16x32_bf16 v[48:51], a[160:163], v[144:147], v[48:51]
    v_fma_f32 v136, v136, s31, -v194
    v_add_u32 v169, s28, v169
    v_mfma_f32_16x16x32_bf16 v[48:51], a[164:167], v[152:155], v[48:51]
    v_exp_f32 v136, v136
    v_mfma_f32_16x16x32_bf16 v[52:55], a[168:171], v[144:147], v[52:55]
    v_fma_f32 v137, v137, s31, -v194
    v_cvt_pk_bf16_f32 v131, v134, v135
    v_add_u32 v160, s28, v160
    v_mfma_f32_16x16x32_bf16 v[52:55], a[172:175], v[152:155], v[52:55]
    v_exp_f32 v137, v137
    v_mfma_f32_16x16x32_bf16 v[56:59], a[176:179], v[144:147], v[56:59]
    v_fma_f32 v138, v138, s31, -v194
    v_add_u32 v171, s28, v171
    v_mfma_f32_16x16x32_bf16 v[56:59], a[180:183], v[152:155], v[56:59]
    v_exp_f32 v138, v138
    v_mfma_f32_16x16x32_bf16 v[60:63], a[184:187], v[144:147], v[60:63]
    v_fma_f32 v139, v139, s31, -v194
    v_cvt_pk_bf16_f32 v136, v136, v137
    v_mfma_f32_16x16x32_bf16 v[60:63], a[188:191], v[152:155], v[60:63]
    v_exp_f32 v139, v139
    v_mfma_f32_16x16x32_bf16 a[196:199], a[208:211], v[144:147], a[196:199]
    s_add_u32 s27, s27, s28
    v_fma_f32 v140, v140, s31, -v194
    v_cvt_pk_bf16_f32 v137, v138, v139
    v_mfma_f32_16x16x32_bf16 a[196:199], a[208:211], v[152:155], a[196:199]
    v_exp_f32 v140, v140
    v_mfma_f32_16x16x32_bf16 v[144:147], a[64:67], a[48:51], 0
    v_fma_f32 v141, v141, s31, -v194
    s_waitcnt vmcnt(16)
    s_barrier
    v_mfma_f32_16x16x32_bf16 v[144:147], a[68:71], a[52:55], v[144:147]
    v_exp_f32 v141, v141
    v_mfma_f32_16x16x32_bf16 v[144:147], a[72:75], a[56:59], v[144:147]
    ds_read_b128 a[64:67], v160
    v_fma_f32 v142, v142, s31, -v194
    v_mfma_f32_16x16x32_bf16 v[144:147], a[76:79], a[60:63], v[144:147]
    s_mov_b32 m0, s29
    v_exp_f32 v142, v142
    v_cvt_pk_bf16_f32 v138, v140, v141
    v_mfma_f32_16x16x32_bf16 v[148:151], a[80:83], a[48:51], 0
    buffer_load_dwordx4 v184, s[8:11], s25 offen nt lds
    v_fma_f32 v143, v143, s31, -v194
    v_mfma_f32_16x16x32_bf16 v[148:151], a[84:87], a[52:55], v[148:151]
    v_exp_f32 v143, v143
    v_mfma_f32_16x16x32_bf16 v[148:151], a[88:91], a[56:59], v[148:151]
    buffer_load_dwordx4 v185, s[8:11], s25 offen offset:1024 nt lds
    v_mfma_f32_16x16x32_bf16 v[148:151], a[92:95], a[60:63], v[148:151]
    buffer_load_dwordx4 v186, s[8:11], s25 offen offset:2048 nt lds
    v_mfma_f32_16x16x32_bf16 v[152:155], a[96:99], a[48:51], 0
    buffer_load_dwordx4 v187, s[8:11], s25 offen offset:3072 nt lds
    v_fma_f32 v144, v144, s31, -v195
    v_mfma_f32_16x16x32_bf16 v[152:155], a[100:103], a[52:55], v[152:155]
    s_add_u32 m0, s29, 49152
    v_exp_f32 v144, v144
    v_cvt_pk_bf16_f32 v139, v142, v143
    v_mfma_f32_16x16x32_bf16 v[152:155], a[104:107], a[56:59], v[152:155]
    buffer_load_dwordx4 v188, s[12:15], s25 offen nt lds
    v_fma_f32 v145, v145, s31, -v195
    v_mfma_f32_16x16x32_bf16 v[152:155], a[108:111], a[60:63], v[152:155]
    v_exp_f32 v145, v145
    v_mfma_f32_16x16x32_bf16 v[156:159], a[112:115], a[48:51], 0
    ds_read_b128 a[68:71], v161
    v_fma_f32 v146, v146, s31, -v195
    v_mfma_f32_16x16x32_bf16 v[156:159], a[116:119], a[52:55], v[156:159]
    ds_read_b128 a[72:75], v162
    v_exp_f32 v146, v146
    v_mfma_f32_16x16x32_bf16 v[156:159], a[120:123], a[56:59], v[156:159]
    buffer_load_dwordx4 v188, s[12:15], s25 offen offset:1024 nt lds
    v_fma_f32 v147, v147, s31, -v195
    v_mfma_f32_16x16x32_bf16 v[156:159], a[124:127], a[60:63], v[156:159]
    ds_read_b128 a[76:79], v163
    v_exp_f32 v147, v147
    v_cvt_pk_bf16_f32 v144, v144, v145
    v_mfma_f32_16x16x32_bf16 v[64:67], a[128:131], v[128:131], v[64:67]
    ds_read_b128 a[80:83], v160 offset:4096
    v_fma_f32 v148, v148, s31, -v195
    v_mfma_f32_16x16x32_bf16 v[64:67], a[132:135], v[136:139], v[64:67]
    v_exp_f32 v148, v148
    v_cvt_pk_bf16_f32 v145, v146, v147
    v_mfma_f32_16x16x32_bf16 v[68:71], a[136:139], v[128:131], v[68:71]
    ds_read_b128 a[84:87], v161 offset:4096
    v_fma_f32 v149, v149, s31, -v195
    v_mfma_f32_16x16x32_bf16 v[68:71], a[140:143], v[136:139], v[68:71]
    v_exp_f32 v149, v149
    v_mfma_f32_16x16x32_bf16 v[72:75], a[144:147], v[128:131], v[72:75]
    ds_read_b128 a[88:91], v162 offset:4096
    ds_read_b128 a[92:95], v163 offset:4096
    v_fma_f32 v150, v150, s31, -v195
    v_mfma_f32_16x16x32_bf16 v[72:75], a[148:151], v[136:139], v[72:75]
    ds_read_b128 a[96:99], v160 offset:8192
    v_exp_f32 v150, v150
    v_mfma_f32_16x16x32_bf16 v[76:79], a[152:155], v[128:131], v[76:79]
    buffer_load_dwordx4 v188, s[12:15], s25 offen offset:2048 nt lds
    v_fma_f32 v151, v151, s31, -v195
    v_mfma_f32_16x16x32_bf16 v[76:79], a[156:159], v[136:139], v[76:79]
    v_exp_f32 v151, v151
    v_cvt_pk_bf16_f32 v146, v148, v149
    v_mfma_f32_16x16x32_bf16 v[80:83], a[160:163], v[128:131], v[80:83]
    buffer_load_dwordx4 v188, s[12:15], s25 offen offset:3072 nt lds
    v_fma_f32 v152, v152, s31, -v195
    v_mfma_f32_16x16x32_bf16 v[80:83], a[164:167], v[136:139], v[80:83]
    v_exp_f32 v152, v152
    v_cvt_pk_bf16_f32 v147, v150, v151
    v_mfma_f32_16x16x32_bf16 v[84:87], a[168:171], v[128:131], v[84:87]
    ds_read_b128 a[100:103], v161 offset:8192
    v_fma_f32 v153, v153, s31, -v195
    v_mfma_f32_16x16x32_bf16 v[84:87], a[172:175], v[136:139], v[84:87]
    v_exp_f32 v153, v153
    v_mfma_f32_16x16x32_bf16 v[88:91], a[176:179], v[128:131], v[88:91]
    ds_read_b128 a[104:107], v162 offset:8192
    ds_read_b128 a[108:111], v163 offset:8192
    v_fma_f32 v154, v154, s31, -v195
    v_mfma_f32_16x16x32_bf16 v[88:91], a[180:183], v[136:139], v[88:91]
    v_exp_f32 v154, v154
    v_cvt_pk_bf16_f32 v152, v152, v153
    v_mfma_f32_16x16x32_bf16 v[92:95], a[184:187], v[128:131], v[92:95]
    ds_read_b128 a[112:115], v160 offset:12288
    v_fma_f32 v155, v155, s31, -v195
    v_mfma_f32_16x16x32_bf16 v[92:95], a[188:191], v[136:139], v[92:95]
    ds_read_b128 a[116:119], v161 offset:12288
    v_exp_f32 v155, v155
    v_mfma_f32_16x16x32_bf16 a[200:203], a[208:211], v[128:131], a[200:203]
    ds_read_b128 a[120:123], v162 offset:12288
    ds_read_b128 a[124:127], v163 offset:12288
    v_fma_f32 v156, v156, s31, -v195
    v_mfma_f32_16x16x32_bf16 a[200:203], a[208:211], v[136:139], a[200:203]
    s_waitcnt lgkmcnt(12)
    v_exp_f32 v156, v156
    v_mfma_f32_16x16x32_bf16 v[128:131], a[64:67], a[0:3], 0
    v_fma_f32 v157, v157, s31, -v195
    v_cvt_pk_bf16_f32 v153, v154, v155
    v_mfma_f32_16x16x32_bf16 v[128:131], a[68:71], a[4:7], v[128:131]
    s_add_u32 s4, s4, 16384
    v_exp_f32 v157, v157
    v_mfma_f32_16x16x32_bf16 v[128:131], a[72:75], a[8:11], v[128:131]
    s_and_b32 s4, s4, 0x1ffff
    v_fma_f32 v158, v158, s31, -v195
    v_cvt_pk_bf16_f32 v154, v156, v157
    v_mfma_f32_16x16x32_bf16 v[128:131], a[76:79], a[12:15], v[128:131]
    s_waitcnt lgkmcnt(8)
    v_exp_f32 v158, v158
    v_mfma_f32_16x16x32_bf16 v[132:135], a[80:83], a[0:3], 0
    s_add_u32 s3, s3, 2097152
    v_fma_f32 v159, v159, s31, -v195
    v_mfma_f32_16x16x32_bf16 v[132:135], a[84:87], a[4:7], v[132:135]
    s_add_u32 s25, s3, s4
    v_exp_f32 v159, v159
    v_mfma_f32_16x16x32_bf16 v[132:135], a[88:91], a[8:11], v[132:135]
    v_cvt_pk_bf16_f32 v155, v158, v159
    v_mfma_f32_16x16x32_bf16 v[132:135], a[92:95], a[12:15], v[132:135]
    s_waitcnt lgkmcnt(4)
    v_mfma_f32_16x16x32_bf16 v[136:139], a[96:99], a[0:3], 0
    v_fma_f32 v128, v128, s31, -v192
    v_mfma_f32_16x16x32_bf16 v[136:139], a[100:103], a[4:7], v[136:139]
    s_add_u32 s39, s27, 16384
    v_exp_f32 v128, v128
    v_mfma_f32_16x16x32_bf16 v[136:139], a[104:107], a[8:11], v[136:139]
    v_fma_f32 v129, v129, s31, -v192
    v_mfma_f32_16x16x32_bf16 v[136:139], a[108:111], a[12:15], v[136:139]
    s_waitcnt lgkmcnt(0)
    v_exp_f32 v129, v129
    v_mfma_f32_16x16x32_bf16 v[140:143], a[112:115], a[0:3], 0
    v_fma_f32 v130, v130, s31, -v192
    v_cvt_pk_bf16_f32 v128, v128, v129
    v_mfma_f32_16x16x32_bf16 v[140:143], a[116:119], a[4:7], v[140:143]
    s_cmp_eq_u32 s39, 49152
    s_cselect_b32 s39, 0, s39
    v_exp_f32 v130, v130
    v_mfma_f32_16x16x32_bf16 v[140:143], a[120:123], a[8:11], v[140:143]
    s_sub_u32 s28, s39, s27
    v_fma_f32 v131, v131, s31, -v192
    v_mfma_f32_16x16x32_bf16 v[140:143], a[124:127], a[12:15], v[140:143]
    v_exp_f32 v131, v131
    v_mfma_f32_16x16x32_bf16 v[96:99], a[128:131], v[144:147], v[96:99]
    v_fma_f32 v132, v132, s31, -v192
    v_cvt_pk_bf16_f32 v129, v130, v131
    v_mfma_f32_16x16x32_bf16 v[96:99], a[132:135], v[152:155], v[96:99]
    v_exp_f32 v132, v132
    v_mfma_f32_16x16x32_bf16 v[100:103], a[136:139], v[144:147], v[100:103]
    ds_read_b64_tr_b16 a[128:129], v168
    ds_read_b64_tr_b16 a[130:131], v168 offset:4096
    v_fma_f32 v133, v133, s31, -v192
    v_mfma_f32_16x16x32_bf16 v[100:103], a[140:143], v[152:155], v[100:103]
    ds_read_b64_tr_b16 a[132:133], v168 offset:8192
    v_exp_f32 v133, v133
    v_mfma_f32_16x16x32_bf16 v[104:107], a[144:147], v[144:147], v[104:107]
    s_add_u32 s29, s27, s50
    ds_read_b64_tr_b16 a[134:135], v168 offset:12288
    ds_read_b64_tr_b16 a[136:137], v168 offset:8
    v_fma_f32 v134, v134, s31, -v192
    v_mfma_f32_16x16x32_bf16 v[104:107], a[148:151], v[152:155], v[104:107]
    v_exp_f32 v134, v134
    v_mfma_f32_16x16x32_bf16 v[108:111], a[152:155], v[144:147], v[108:111]
    s_cmp_eq_u32 s30, 3
    s_cselect_b32 s10, 0, s10
    s_cselect_b32 s14, 0, s14
    v_fma_f32 v135, v135, s31, -v192
    v_mfma_f32_16x16x32_bf16 v[108:111], a[156:159], v[152:155], v[108:111]
    v_exp_f32 v135, v135
    v_cvt_pk_bf16_f32 v130, v132, v133
    v_mfma_f32_16x16x32_bf16 v[112:115], a[160:163], v[144:147], v[112:115]
    ds_read_b64_tr_b16 a[138:139], v168 offset:4104
    v_fma_f32 v136, v136, s31, -v192
    v_mfma_f32_16x16x32_bf16 v[112:115], a[164:167], v[152:155], v[112:115]
    ds_read_b64_tr_b16 a[140:141], v168 offset:8200
    v_exp_f32 v136, v136
    v_mfma_f32_16x16x32_bf16 v[116:119], a[168:171], v[144:147], v[116:119]
    ds_read_b64_tr_b16 a[142:143], v168 offset:12296
    v_fma_f32 v137, v137, s31, -v192
    v_mfma_f32_16x16x32_bf16 v[116:119], a[172:175], v[152:155], v[116:119]
    v_exp_f32 v137, v137
    v_cvt_pk_bf16_f32 v131, v134, v135
    v_mfma_f32_16x16x32_bf16 v[120:123], a[176:179], v[144:147], v[120:123]
    v_fma_f32 v138, v138, s31, -v192
    v_cvt_pk_bf16_f32 v136, v136, v137
    v_mfma_f32_16x16x32_bf16 v[120:123], a[180:183], v[152:155], v[120:123]
    v_exp_f32 v138, v138
    v_mfma_f32_16x16x32_bf16 v[124:127], a[184:187], v[144:147], v[124:127]
    ds_read_b64_tr_b16 a[144:145], v169
    ds_read_b64_tr_b16 a[146:147], v169 offset:4096
    v_fma_f32 v139, v139, s31, -v192
    v_mfma_f32_16x16x32_bf16 v[124:127], a[188:191], v[152:155], v[124:127]
    v_exp_f32 v139, v139
    v_mfma_f32_16x16x32_bf16 a[204:207], a[208:211], v[144:147], a[204:207]
    ds_read_b64_tr_b16 a[148:149], v169 offset:8192
    v_fma_f32 v140, v140, s31, -v192
    v_mfma_f32_16x16x32_bf16 a[204:207], a[208:211], v[152:155], a[204:207]
    ds_read_b64_tr_b16 a[150:151], v169 offset:12288
    v_exp_f32 v140, v140
    v_mfma_f32_16x16x32_bf16 v[144:147], a[64:67], a[16:19], 0
    ds_read_b64_tr_b16 a[152:153], v169 offset:8
    v_fma_f32 v141, v141, s31, -v192
    v_mfma_f32_16x16x32_bf16 v[144:147], a[68:71], a[20:23], v[144:147]
    ds_read_b64_tr_b16 a[154:155], v169 offset:4104
    v_exp_f32 v141, v141
    v_cvt_pk_bf16_f32 v137, v138, v139
    v_mfma_f32_16x16x32_bf16 v[144:147], a[72:75], a[24:27], v[144:147]
    ds_read_b64_tr_b16 a[156:157], v169 offset:8200
    v_fma_f32 v142, v142, s31, -v192
    v_mfma_f32_16x16x32_bf16 v[144:147], a[76:79], a[28:31], v[144:147]
    v_exp_f32 v142, v142
    v_mfma_f32_16x16x32_bf16 v[148:151], a[80:83], a[16:19], 0
    ds_read_b64_tr_b16 a[158:159], v169 offset:12296
    v_fma_f32 v143, v143, s31, -v192
    v_cvt_pk_bf16_f32 v138, v140, v141
    v_mfma_f32_16x16x32_bf16 v[148:151], a[84:87], a[20:23], v[148:151]
    ds_read_b64_tr_b16 a[160:161], v170
    v_exp_f32 v143, v143
    v_mfma_f32_16x16x32_bf16 v[148:151], a[88:91], a[24:27], v[148:151]
    ds_read_b64_tr_b16 a[162:163], v170 offset:4096
    ds_read_b64_tr_b16 a[164:165], v170 offset:8192
    v_mfma_f32_16x16x32_bf16 v[148:151], a[92:95], a[28:31], v[148:151]
    buffer_store_dwordx4 a[220:223], v186, s[20:23], s37 offen offset:2048 sc1 nt
    v_mfma_f32_16x16x32_bf16 v[152:155], a[96:99], a[16:19], 0
    ds_read_b64_tr_b16 a[166:167], v170 offset:12288
    ds_read_b64_tr_b16 a[168:169], v170 offset:8
    v_fma_f32 v144, v144, s31, -v193
    v_mfma_f32_16x16x32_bf16 v[152:155], a[100:103], a[20:23], v[152:155]
    v_exp_f32 v144, v144
    v_cvt_pk_bf16_f32 v139, v142, v143
    v_mfma_f32_16x16x32_bf16 v[152:155], a[104:107], a[24:27], v[152:155]
    ds_read_b64_tr_b16 a[170:171], v170 offset:4104
    v_fma_f32 v145, v145, s31, -v193
    v_mfma_f32_16x16x32_bf16 v[152:155], a[108:111], a[28:31], v[152:155]
    ds_read_b64_tr_b16 a[172:173], v170 offset:8200
    v_exp_f32 v145, v145
    v_mfma_f32_16x16x32_bf16 v[156:159], a[112:115], a[16:19], 0
    ds_read_b64_tr_b16 a[174:175], v170 offset:12296
    ds_read_b64_tr_b16 a[176:177], v171
    v_fma_f32 v146, v146, s31, -v193
    v_mfma_f32_16x16x32_bf16 v[156:159], a[116:119], a[20:23], v[156:159]
    ds_read_b64_tr_b16 a[178:179], v171 offset:4096
    v_exp_f32 v146, v146
    v_mfma_f32_16x16x32_bf16 v[156:159], a[120:123], a[24:27], v[156:159]
    ds_read_b64_tr_b16 a[180:181], v171 offset:8192
    v_fma_f32 v147, v147, s31, -v193
    v_cvt_pk_bf16_f32 v144, v144, v145
    v_mfma_f32_16x16x32_bf16 v[156:159], a[124:127], a[28:31], v[156:159]
    s_waitcnt lgkmcnt(15)
    v_exp_f32 v147, v147
    v_mfma_f32_16x16x32_bf16 v[0:3], a[128:131], v[128:131], v[0:3]
    ds_read_b64_tr_b16 a[182:183], v171 offset:12288
    v_fma_f32 v148, v148, s31, -v193
    v_mfma_f32_16x16x32_bf16 v[0:3], a[132:135], v[136:139], v[0:3]
    v_exp_f32 v148, v148
    v_mfma_f32_16x16x32_bf16 v[4:7], a[136:139], v[128:131], v[4:7]
    v_fma_f32 v149, v149, s31, -v193
    v_cvt_pk_bf16_f32 v145, v146, v147
    v_mfma_f32_16x16x32_bf16 v[4:7], a[140:143], v[136:139], v[4:7]
    v_exp_f32 v149, v149
    v_mfma_f32_16x16x32_bf16 v[8:11], a[144:147], v[128:131], v[8:11]
    v_fma_f32 v150, v150, s31, -v193
    v_cvt_pk_bf16_f32 v146, v148, v149
    v_mfma_f32_16x16x32_bf16 v[8:11], a[148:151], v[136:139], v[8:11]
    s_waitcnt lgkmcnt(12)
    v_exp_f32 v150, v150
    v_mfma_f32_16x16x32_bf16 v[12:15], a[152:155], v[128:131], v[12:15]
    ds_read_b64_tr_b16 a[184:185], v171 offset:8
    v_fma_f32 v151, v151, s31, -v193
    v_mfma_f32_16x16x32_bf16 v[12:15], a[156:159], v[136:139], v[12:15]
    s_waitcnt lgkmcnt(9)
    ds_read_b64_tr_b16 a[186:187], v171 offset:4104
    v_exp_f32 v151, v151
    v_mfma_f32_16x16x32_bf16 v[16:19], a[160:163], v[128:131], v[16:19]
    ds_read_b64_tr_b16 a[188:189], v171 offset:8200
    v_fma_f32 v152, v152, s31, -v193
    v_mfma_f32_16x16x32_bf16 v[16:19], a[164:167], v[136:139], v[16:19]
    s_waitcnt lgkmcnt(7)
    ds_read_b64_tr_b16 a[190:191], v171 offset:12296
    v_exp_f32 v152, v152
    v_mfma_f32_16x16x32_bf16 v[20:23], a[168:171], v[128:131], v[20:23]
    v_fma_f32 v153, v153, s31, -v193
    v_cvt_pk_bf16_f32 v147, v150, v151
    v_mfma_f32_16x16x32_bf16 v[20:23], a[172:175], v[136:139], v[20:23]
    s_waitcnt lgkmcnt(4)
    v_exp_f32 v153, v153
    v_mfma_f32_16x16x32_bf16 v[24:27], a[176:179], v[128:131], v[24:27]
    v_fma_f32 v154, v154, s31, -v193
    v_add_u32 v160, s28, v160
    v_mfma_f32_16x16x32_bf16 v[24:27], a[180:183], v[136:139], v[24:27]
    s_waitcnt lgkmcnt(0)
    v_exp_f32 v154, v154
    v_mfma_f32_16x16x32_bf16 v[28:31], a[184:187], v[128:131], v[28:31]
    v_fma_f32 v155, v155, s31, -v193
    v_cvt_pk_bf16_f32 v152, v152, v153
    v_mfma_f32_16x16x32_bf16 v[28:31], a[188:191], v[136:139], v[28:31]
    v_exp_f32 v155, v155
    v_mfma_f32_16x16x32_bf16 a[192:195], a[208:211], v[128:131], a[192:195]
    v_fma_f32 v156, v156, s31, -v193
    v_cvt_pk_bf16_f32 v153, v154, v155
    v_mfma_f32_16x16x32_bf16 a[192:195], a[208:211], v[136:139], a[192:195]
    s_add_u32 m0, s34, 8192
    v_exp_f32 v156, v156
    v_mfma_f32_16x16x32_bf16 v[128:131], a[64:67], a[32:35], 0
    buffer_load_dwordx4 v186, s[16:19], s37 offen offset:2048 nt lds
    v_fma_f32 v157, v157, s31, -v193
    v_mfma_f32_16x16x32_bf16 v[128:131], a[68:71], a[36:39], v[128:131]
    v_exp_f32 v157, v157
    v_mfma_f32_16x16x32_bf16 v[128:131], a[72:75], a[40:43], v[128:131]
    v_fma_f32 v158, v158, s31, -v193
    v_cvt_pk_bf16_f32 v154, v156, v157
    v_mfma_f32_16x16x32_bf16 v[128:131], a[76:79], a[44:47], v[128:131]
    s_add_u32 m0, s34, 8192
    v_exp_f32 v158, v158
    v_mfma_f32_16x16x32_bf16 v[132:135], a[80:83], a[32:35], 0
    buffer_load_dwordx4 v187, s[16:19], s37 offen offset:3072 nt lds
    v_fma_f32 v159, v159, s31, -v193
    v_mfma_f32_16x16x32_bf16 v[132:135], a[84:87], a[36:39], v[132:135]
    v_exp_f32 v159, v159
    v_mfma_f32_16x16x32_bf16 v[132:135], a[88:91], a[40:43], v[132:135]
    s_and_b32 s18, s18, s35
    s_add_u32 m0, s34, 12288
    v_add_u32 v169, s28, v169
    v_mfma_f32_16x16x32_bf16 v[132:135], a[92:95], a[44:47], v[132:135]
    buffer_load_dwordx4 v184, s[16:19], s38 offen nt lds
    v_mfma_f32_16x16x32_bf16 v[136:139], a[96:99], a[32:35], 0
    v_fma_f32 v128, v128, s31, -v194
    v_cvt_pk_bf16_f32 v155, v158, v159
    v_mfma_f32_16x16x32_bf16 v[136:139], a[100:103], a[36:39], v[136:139]
    v_exp_f32 v128, v128
    v_mfma_f32_16x16x32_bf16 v[136:139], a[104:107], a[40:43], v[136:139]
    v_fma_f32 v129, v129, s31, -v194
    v_add_u32 v161, s28, v161
    v_mfma_f32_16x16x32_bf16 v[136:139], a[108:111], a[44:47], v[136:139]
    v_exp_f32 v129, v129
    v_mfma_f32_16x16x32_bf16 v[140:143], a[112:115], a[32:35], 0
    v_fma_f32 v130, v130, s31, -v194
    v_cvt_pk_bf16_f32 v128, v128, v129
    v_mfma_f32_16x16x32_bf16 v[140:143], a[116:119], a[36:39], v[140:143]
    v_exp_f32 v130, v130
    v_mfma_f32_16x16x32_bf16 v[140:143], a[120:123], a[40:43], v[140:143]
    v_fma_f32 v131, v131, s31, -v194
    v_add_u32 v170, s28, v170
    v_mfma_f32_16x16x32_bf16 v[140:143], a[124:127], a[44:47], v[140:143]
    v_exp_f32 v131, v131
    v_mfma_f32_16x16x32_bf16 v[32:35], a[128:131], v[144:147], v[32:35]
    v_fma_f32 v132, v132, s31, -v194
    v_cvt_pk_bf16_f32 v129, v130, v131
    v_mfma_f32_16x16x32_bf16 v[32:35], a[132:135], v[152:155], v[32:35]
    v_exp_f32 v132, v132
    v_mfma_f32_16x16x32_bf16 v[36:39], a[136:139], v[144:147], v[36:39]
    buffer_store_dwordx4 a[224:227], v187, s[20:23], s37 offen offset:3072 sc1 nt
    v_fma_f32 v133, v133, s31, -v194
    v_mfma_f32_16x16x32_bf16 v[36:39], a[140:143], v[152:155], v[36:39]
    v_exp_f32 v133, v133
    v_mfma_f32_16x16x32_bf16 v[40:43], a[144:147], v[144:147], v[40:43]
    v_fma_f32 v134, v134, s31, -v194
    v_cvt_pk_bf16_f32 v130, v132, v133
    v_mfma_f32_16x16x32_bf16 v[40:43], a[148:151], v[152:155], v[40:43]
    v_exp_f32 v134, v134
    v_mfma_f32_16x16x32_bf16 v[44:47], a[152:155], v[144:147], v[44:47]
    v_fma_f32 v135, v135, s31, -v194
    v_add_u32 v171, s28, v171
    v_mfma_f32_16x16x32_bf16 v[44:47], a[156:159], v[152:155], v[44:47]
    v_exp_f32 v135, v135
    v_mfma_f32_16x16x32_bf16 v[48:51], a[160:163], v[144:147], v[48:51]
    v_fma_f32 v136, v136, s31, -v194
    v_add_u32 v168, s28, v168
    v_mfma_f32_16x16x32_bf16 v[48:51], a[164:167], v[152:155], v[48:51]
    v_exp_f32 v136, v136
    v_mfma_f32_16x16x32_bf16 v[52:55], a[168:171], v[144:147], v[52:55]
    v_fma_f32 v137, v137, s31, -v194
    v_cvt_pk_bf16_f32 v131, v134, v135
    v_mfma_f32_16x16x32_bf16 v[52:55], a[172:175], v[152:155], v[52:55]
    v_exp_f32 v137, v137
    v_mfma_f32_16x16x32_bf16 v[56:59], a[176:179], v[144:147], v[56:59]
    v_fma_f32 v138, v138, s31, -v194
    v_add_u32 v163, s28, v163
    v_mfma_f32_16x16x32_bf16 v[56:59], a[180:183], v[152:155], v[56:59]
    v_exp_f32 v138, v138
    v_mfma_f32_16x16x32_bf16 v[60:63], a[184:187], v[144:147], v[60:63]
    v_fma_f32 v139, v139, s31, -v194
    v_cvt_pk_bf16_f32 v136, v136, v137
    v_mfma_f32_16x16x32_bf16 v[60:63], a[188:191], v[152:155], v[60:63]
    v_exp_f32 v139, v139
    v_mfma_f32_16x16x32_bf16 a[196:199], a[208:211], v[144:147], a[196:199]
    s_add_u32 s27, s27, s28
    v_fma_f32 v140, v140, s31, -v194
    v_cvt_pk_bf16_f32 v137, v138, v139
    v_add_u32 v162, s28, v162
    v_mfma_f32_16x16x32_bf16 a[196:199], a[208:211], v[152:155], a[196:199]
    v_exp_f32 v140, v140
    v_mfma_f32_16x16x32_bf16 v[144:147], a[64:67], a[48:51], 0
    v_fma_f32 v141, v141, s31, -v194
    s_waitcnt vmcnt(17)
    s_barrier
    v_mfma_f32_16x16x32_bf16 v[144:147], a[68:71], a[52:55], v[144:147]
    s_mov_b32 m0, s29
    v_exp_f32 v141, v141
    v_mfma_f32_16x16x32_bf16 v[144:147], a[72:75], a[56:59], v[144:147]
    buffer_load_dwordx4 v184, s[8:11], s25 offen nt lds
    v_fma_f32 v142, v142, s31, -v194
    v_mfma_f32_16x16x32_bf16 v[144:147], a[76:79], a[60:63], v[144:147]
    v_exp_f32 v142, v142
    v_cvt_pk_bf16_f32 v138, v140, v141
    v_mfma_f32_16x16x32_bf16 v[148:151], a[80:83], a[48:51], 0
    ds_read_b128 a[64:67], v160
    ds_read_b128 a[68:71], v161
    v_fma_f32 v143, v143, s31, -v194
    v_mfma_f32_16x16x32_bf16 v[148:151], a[84:87], a[52:55], v[148:151]
    v_exp_f32 v143, v143
    v_mfma_f32_16x16x32_bf16 v[148:151], a[88:91], a[56:59], v[148:151]
    ds_read_b128 a[72:75], v162
    ds_read_b128 a[76:79], v163
    ds_read_b128 a[80:83], v160 offset:4096
    v_mfma_f32_16x16x32_bf16 v[148:151], a[92:95], a[60:63], v[148:151]
    buffer_load_dwordx4 v185, s[8:11], s25 offen offset:1024 nt lds
    v_mfma_f32_16x16x32_bf16 v[152:155], a[96:99], a[48:51], 0
    ds_read_b128 a[84:87], v161 offset:4096
    ds_read_b128 a[88:91], v162 offset:4096
    v_fma_f32 v144, v144, s31, -v195
    v_mfma_f32_16x16x32_bf16 v[152:155], a[100:103], a[52:55], v[152:155]
    v_exp_f32 v144, v144
    v_cvt_pk_bf16_f32 v139, v142, v143
    v_mfma_f32_16x16x32_bf16 v[152:155], a[104:107], a[56:59], v[152:155]
    ds_read_b128 a[92:95], v163 offset:4096
    ds_read_b128 a[96:99], v160 offset:8192
    v_fma_f32 v145, v145, s31, -v195
    v_mfma_f32_16x16x32_bf16 v[152:155], a[108:111], a[60:63], v[152:155]
    buffer_load_dwordx4 v186, s[8:11], s25 offen offset:2048 nt lds
    v_exp_f32 v145, v145
    v_mfma_f32_16x16x32_bf16 v[156:159], a[112:115], a[48:51], 0
    ds_read_b128 a[100:103], v161 offset:8192
    v_fma_f32 v146, v146, s31, -v195
    v_cvt_pk_bf16_f32 v144, v144, v145
    v_mfma_f32_16x16x32_bf16 v[156:159], a[116:119], a[52:55], v[156:159]
    v_exp_f32 v146, v146
    v_mfma_f32_16x16x32_bf16 v[156:159], a[120:123], a[56:59], v[156:159]
    buffer_load_dwordx4 v187, s[8:11], s25 offen offset:3072 nt lds
    v_fma_f32 v147, v147, s31, -v195
    v_mfma_f32_16x16x32_bf16 v[156:159], a[124:127], a[60:63], v[156:159]
    s_add_u32 m0, s29, 49152
    v_exp_f32 v147, v147
    v_mfma_f32_16x16x32_bf16 v[64:67], a[128:131], v[128:131], v[64:67]
    buffer_load_dwordx4 v188, s[12:15], s25 offen nt lds
    v_fma_f32 v148, v148, s31, -v195
    v_mfma_f32_16x16x32_bf16 v[64:67], a[132:135], v[136:139], v[64:67]
    v_exp_f32 v148, v148
    v_cvt_pk_bf16_f32 v145, v146, v147
    v_mfma_f32_16x16x32_bf16 v[68:71], a[136:139], v[128:131], v[68:71]
    buffer_load_dwordx4 v188, s[12:15], s25 offen offset:1024 nt lds
    v_fma_f32 v149, v149, s31, -v195
    v_mfma_f32_16x16x32_bf16 v[68:71], a[140:143], v[136:139], v[68:71]
    v_exp_f32 v149, v149
    v_mfma_f32_16x16x32_bf16 v[72:75], a[144:147], v[128:131], v[72:75]
    buffer_load_dwordx4 v188, s[12:15], s25 offen offset:2048 nt lds
    v_fma_f32 v150, v150, s31, -v195
    v_mfma_f32_16x16x32_bf16 v[72:75], a[148:151], v[136:139], v[72:75]
    v_exp_f32 v150, v150
    v_mfma_f32_16x16x32_bf16 v[76:79], a[152:155], v[128:131], v[76:79]
    v_fma_f32 v151, v151, s31, -v195
    v_cvt_pk_bf16_f32 v146, v148, v149
    v_mfma_f32_16x16x32_bf16 v[76:79], a[156:159], v[136:139], v[76:79]
    ds_read_b128 a[104:107], v162 offset:8192
    v_exp_f32 v151, v151
    v_mfma_f32_16x16x32_bf16 v[80:83], a[160:163], v[128:131], v[80:83]
    buffer_load_dwordx4 v188, s[12:15], s25 offen offset:3072 nt lds
    v_fma_f32 v152, v152, s31, -v195
    v_mfma_f32_16x16x32_bf16 v[80:83], a[164:167], v[136:139], v[80:83]
    v_exp_f32 v152, v152
    v_mfma_f32_16x16x32_bf16 v[84:87], a[168:171], v[128:131], v[84:87]
    v_fma_f32 v153, v153, s31, -v195
    v_cvt_pk_bf16_f32 v147, v150, v151
    v_mfma_f32_16x16x32_bf16 v[84:87], a[172:175], v[136:139], v[84:87]
    ds_read_b128 a[108:111], v163 offset:8192
    v_exp_f32 v153, v153
    v_mfma_f32_16x16x32_bf16 v[88:91], a[176:179], v[128:131], v[88:91]
    v_fma_f32 v154, v154, s31, -v195
    v_cvt_pk_bf16_f32 v152, v152, v153
    v_mfma_f32_16x16x32_bf16 v[88:91], a[180:183], v[136:139], v[88:91]
    v_exp_f32 v154, v154
    v_mfma_f32_16x16x32_bf16 v[92:95], a[184:187], v[128:131], v[92:95]
    ds_read_b128 a[112:115], v160 offset:12288
    v_fma_f32 v155, v155, s31, -v195
    v_mfma_f32_16x16x32_bf16 v[92:95], a[188:191], v[136:139], v[92:95]
    ds_read_b128 a[116:119], v161 offset:12288
    v_exp_f32 v155, v155
    v_mfma_f32_16x16x32_bf16 a[200:203], a[208:211], v[128:131], a[200:203]
    ds_read_b128 a[120:123], v162 offset:12288
    ds_read_b128 a[124:127], v163 offset:12288
    v_fma_f32 v156, v156, s31, -v195
    v_mfma_f32_16x16x32_bf16 a[200:203], a[208:211], v[136:139], a[200:203]
    s_waitcnt lgkmcnt(12)
    v_exp_f32 v156, v156
    v_mfma_f32_16x16x32_bf16 v[128:131], a[64:67], a[0:3], 0
    v_fma_f32 v157, v157, s31, -v195
    v_cvt_pk_bf16_f32 v153, v154, v155
    v_mfma_f32_16x16x32_bf16 v[128:131], a[68:71], a[4:7], v[128:131]
    s_add_u32 s4, s4, 16384
    v_exp_f32 v157, v157
    v_mfma_f32_16x16x32_bf16 v[128:131], a[72:75], a[8:11], v[128:131]
    s_and_b32 s4, s4, 0x1ffff
    v_fma_f32 v158, v158, s31, -v195
    v_mfma_f32_16x16x32_bf16 v[128:131], a[76:79], a[12:15], v[128:131]
    s_waitcnt lgkmcnt(8)
    v_exp_f32 v158, v158
    v_mfma_f32_16x16x32_bf16 v[132:135], a[80:83], a[0:3], 0
    v_fma_f32 v159, v159, s31, -v195
    v_cvt_pk_bf16_f32 v154, v156, v157
    v_mfma_f32_16x16x32_bf16 v[132:135], a[84:87], a[4:7], v[132:135]
    s_add_u32 s25, s3, s4
    v_exp_f32 v159, v159
    v_mfma_f32_16x16x32_bf16 v[132:135], a[88:91], a[8:11], v[132:135]
    v_cvt_pk_bf16_f32 v155, v158, v159
    v_mfma_f32_16x16x32_bf16 v[132:135], a[92:95], a[12:15], v[132:135]
    s_waitcnt lgkmcnt(4)
    v_mfma_f32_16x16x32_bf16 v[136:139], a[96:99], a[0:3], 0
    v_fma_f32 v128, v128, s31, -v192
    v_mfma_f32_16x16x32_bf16 v[136:139], a[100:103], a[4:7], v[136:139]
    s_add_u32 s39, s27, 16384
    v_exp_f32 v128, v128
    v_mfma_f32_16x16x32_bf16 v[136:139], a[104:107], a[8:11], v[136:139]
    v_fma_f32 v129, v129, s31, -v192
    v_mfma_f32_16x16x32_bf16 v[136:139], a[108:111], a[12:15], v[136:139]
    s_waitcnt lgkmcnt(0)
    v_exp_f32 v129, v129
    v_mfma_f32_16x16x32_bf16 v[140:143], a[112:115], a[0:3], 0
    v_fma_f32 v130, v130, s31, -v192
    v_mfma_f32_16x16x32_bf16 v[140:143], a[116:119], a[4:7], v[140:143]
    s_cmp_eq_u32 s39, 49152
    s_cselect_b32 s39, 0, s39
    v_exp_f32 v130, v130
    v_mfma_f32_16x16x32_bf16 v[140:143], a[120:123], a[8:11], v[140:143]
    s_sub_u32 s28, s39, s27
    v_fma_f32 v131, v131, s31, -v192
    v_cvt_pk_bf16_f32 v128, v128, v129
    v_mfma_f32_16x16x32_bf16 v[140:143], a[124:127], a[12:15], v[140:143]
    v_exp_f32 v131, v131
    v_mfma_f32_16x16x32_bf16 v[96:99], a[128:131], v[144:147], v[96:99]
    v_fma_f32 v132, v132, s31, -v192
    v_cvt_pk_bf16_f32 v129, v130, v131
    v_mfma_f32_16x16x32_bf16 v[96:99], a[132:135], v[152:155], v[96:99]
    v_exp_f32 v132, v132
    v_mfma_f32_16x16x32_bf16 v[100:103], a[136:139], v[144:147], v[100:103]
    ds_read_b64_tr_b16 a[128:129], v168
    ds_read_b64_tr_b16 a[130:131], v168 offset:4096
    v_fma_f32 v133, v133, s31, -v192
    v_mfma_f32_16x16x32_bf16 v[100:103], a[140:143], v[152:155], v[100:103]
    ds_read_b64_tr_b16 a[132:133], v168 offset:8192
    v_exp_f32 v133, v133
    v_mfma_f32_16x16x32_bf16 v[104:107], a[144:147], v[144:147], v[104:107]
    s_add_u32 s29, s27, s50
    ds_read_b64_tr_b16 a[134:135], v168 offset:12288
    ds_read_b64_tr_b16 a[136:137], v168 offset:8
    v_fma_f32 v134, v134, s31, -v192
    v_mfma_f32_16x16x32_bf16 v[104:107], a[148:151], v[152:155], v[104:107]
    ds_read_b64_tr_b16 a[138:139], v168 offset:4104
    v_exp_f32 v134, v134
    v_mfma_f32_16x16x32_bf16 v[108:111], a[152:155], v[144:147], v[108:111]
    v_fma_f32 v135, v135, s31, -v192
    v_cvt_pk_bf16_f32 v130, v132, v133
    v_mfma_f32_16x16x32_bf16 v[108:111], a[156:159], v[152:155], v[108:111]
    ds_read_b64_tr_b16 a[140:141], v168 offset:8200
    v_exp_f32 v135, v135
    v_mfma_f32_16x16x32_bf16 v[112:115], a[160:163], v[144:147], v[112:115]
    ds_read_b64_tr_b16 a[142:143], v168 offset:12296
    ds_read_b64_tr_b16 a[144:145], v169
    v_fma_f32 v136, v136, s31, -v192
    v_mfma_f32_16x16x32_bf16 v[112:115], a[164:167], v[152:155], v[112:115]
    v_exp_f32 v136, v136
    v_mfma_f32_16x16x32_bf16 v[116:119], a[168:171], v[144:147], v[116:119]
    v_fma_f32 v137, v137, s31, -v192
    v_cvt_pk_bf16_f32 v131, v134, v135
    v_mfma_f32_16x16x32_bf16 v[116:119], a[172:175], v[152:155], v[116:119]
    v_exp_f32 v137, v137
    v_mfma_f32_16x16x32_bf16 v[120:123], a[176:179], v[144:147], v[120:123]
    ds_read_b64_tr_b16 a[146:147], v169 offset:4096
    v_fma_f32 v138, v138, s31, -v192
    v_mfma_f32_16x16x32_bf16 v[120:123], a[180:183], v[152:155], v[120:123]
    v_exp_f32 v138, v138
    v_cvt_pk_bf16_f32 v136, v136, v137
    v_mfma_f32_16x16x32_bf16 v[124:127], a[184:187], v[144:147], v[124:127]
    ds_read_b64_tr_b16 a[148:149], v169 offset:8192
    v_fma_f32 v139, v139, s31, -v192
    v_mfma_f32_16x16x32_bf16 v[124:127], a[188:191], v[152:155], v[124:127]
    ds_read_b64_tr_b16 a[150:151], v169 offset:12288
    v_exp_f32 v139, v139
    v_mfma_f32_16x16x32_bf16 a[204:207], a[208:211], v[144:147], a[204:207]
    ds_read_b64_tr_b16 a[152:153], v169 offset:8
    v_fma_f32 v140, v140, s31, -v192
    v_cvt_pk_bf16_f32 v137, v138, v139
    v_mfma_f32_16x16x32_bf16 a[204:207], a[208:211], v[152:155], a[204:207]
    ds_read_b64_tr_b16 a[154:155], v169 offset:4104
    v_exp_f32 v140, v140
    v_mfma_f32_16x16x32_bf16 v[144:147], a[64:67], a[16:19], 0
    ds_read_b64_tr_b16 a[156:157], v169 offset:8200
    ds_read_b64_tr_b16 a[158:159], v169 offset:12296
    v_fma_f32 v141, v141, s31, -v192
    v_mfma_f32_16x16x32_bf16 v[144:147], a[68:71], a[20:23], v[144:147]
    ds_read_b64_tr_b16 a[160:161], v170
    v_exp_f32 v141, v141
    v_mfma_f32_16x16x32_bf16 v[144:147], a[72:75], a[24:27], v[144:147]
    ds_read_b64_tr_b16 a[162:163], v170 offset:4096
    v_fma_f32 v142, v142, s31, -v192
    v_mfma_f32_16x16x32_bf16 v[144:147], a[76:79], a[28:31], v[144:147]
    v_exp_f32 v142, v142
    v_mfma_f32_16x16x32_bf16 v[148:151], a[80:83], a[16:19], 0
    v_fma_f32 v143, v143, s31, -v192
    v_cvt_pk_bf16_f32 v138, v140, v141
    v_mfma_f32_16x16x32_bf16 v[148:151], a[84:87], a[20:23], v[148:151]
    v_exp_f32 v143, v143
    v_mfma_f32_16x16x32_bf16 v[148:151], a[88:91], a[24:27], v[148:151]
    ds_read_b64_tr_b16 a[164:165], v170 offset:8192
    ds_read_b64_tr_b16 a[166:167], v170 offset:12288
    v_mfma_f32_16x16x32_bf16 v[148:151], a[92:95], a[28:31], v[148:151]
    ds_read_b64_tr_b16 a[168:169], v170 offset:8
    ds_read_b64_tr_b16 a[170:171], v170 offset:4104
    v_mfma_f32_16x16x32_bf16 v[152:155], a[96:99], a[16:19], 0
    v_fma_f32 v144, v144, s31, -v193
    v_cvt_pk_bf16_f32 v139, v142, v143
    v_mfma_f32_16x16x32_bf16 v[152:155], a[100:103], a[20:23], v[152:155]
    v_exp_f32 v144, v144
    v_mfma_f32_16x16x32_bf16 v[152:155], a[104:107], a[24:27], v[152:155]
    s_and_b32 s22, s22, s35
    buffer_store_dwordx4 a[228:231], v184, s[20:23], s38 offen sc1 nt
    v_fma_f32 v145, v145, s31, -v193
    v_mfma_f32_16x16x32_bf16 v[152:155], a[108:111], a[28:31], v[152:155]
    v_exp_f32 v145, v145
    v_mfma_f32_16x16x32_bf16 v[156:159], a[112:115], a[16:19], 0
    ds_read_b64_tr_b16 a[172:173], v170 offset:8200
    v_fma_f32 v146, v146, s31, -v193
    v_mfma_f32_16x16x32_bf16 v[156:159], a[116:119], a[20:23], v[156:159]
    v_exp_f32 v146, v146
    v_mfma_f32_16x16x32_bf16 v[156:159], a[120:123], a[24:27], v[156:159]
    ds_read_b64_tr_b16 a[174:175], v170 offset:12296
    v_fma_f32 v147, v147, s31, -v193
    v_mfma_f32_16x16x32_bf16 v[156:159], a[124:127], a[28:31], v[156:159]
    s_waitcnt lgkmcnt(15)
    v_exp_f32 v147, v147
    v_cvt_pk_bf16_f32 v144, v144, v145
    v_mfma_f32_16x16x32_bf16 v[0:3], a[128:131], v[128:131], v[0:3]
    ds_read_b64_tr_b16 a[176:177], v171
    v_fma_f32 v148, v148, s31, -v193
    v_cvt_pk_bf16_f32 v145, v146, v147
    v_mfma_f32_16x16x32_bf16 v[0:3], a[132:135], v[136:139], v[0:3]
    v_exp_f32 v148, v148
    v_mfma_f32_16x16x32_bf16 v[4:7], a[136:139], v[128:131], v[4:7]
    ds_read_b64_tr_b16 a[178:179], v171 offset:4096
    ds_read_b64_tr_b16 a[180:181], v171 offset:8192
    v_fma_f32 v149, v149, s31, -v193
    v_mfma_f32_16x16x32_bf16 v[4:7], a[140:143], v[136:139], v[4:7]
    s_waitcnt lgkmcnt(15)
    v_exp_f32 v149, v149
    v_mfma_f32_16x16x32_bf16 v[8:11], a[144:147], v[128:131], v[8:11]
    ds_read_b64_tr_b16 a[182:183], v171 offset:12288
    v_fma_f32 v150, v150, s31, -v193
    v_mfma_f32_16x16x32_bf16 v[8:11], a[148:151], v[136:139], v[8:11]
    s_waitcnt lgkmcnt(12)
    v_exp_f32 v150, v150
    v_mfma_f32_16x16x32_bf16 v[12:15], a[152:155], v[128:131], v[12:15]
    ds_read_b64_tr_b16 a[184:185], v171 offset:8
    ds_read_b64_tr_b16 a[186:187], v171 offset:4104
    v_fma_f32 v151, v151, s31, -v193
    v_mfma_f32_16x16x32_bf16 v[12:15], a[156:159], v[136:139], v[12:15]
    s_waitcnt lgkmcnt(10)
    v_exp_f32 v151, v151
    v_cvt_pk_bf16_f32 v146, v148, v149
    v_mfma_f32_16x16x32_bf16 v[16:19], a[160:163], v[128:131], v[16:19]
    ds_read_b64_tr_b16 a[188:189], v171 offset:8200
    ds_read_b64_tr_b16 a[190:191], v171 offset:12296
    v_fma_f32 v152, v152, s31, -v193
    v_mfma_f32_16x16x32_bf16 v[16:19], a[164:167], v[136:139], v[16:19]
    s_waitcnt lgkmcnt(8)
    v_exp_f32 v152, v152
    v_mfma_f32_16x16x32_bf16 v[20:23], a[168:171], v[128:131], v[20:23]
    v_fma_f32 v153, v153, s31, -v193
    v_cvt_pk_bf16_f32 v147, v150, v151
    v_mfma_f32_16x16x32_bf16 v[20:23], a[172:175], v[136:139], v[20:23]
    s_waitcnt lgkmcnt(4)
    v_exp_f32 v153, v153
    v_mfma_f32_16x16x32_bf16 v[24:27], a[176:179], v[128:131], v[24:27]
    v_fma_f32 v154, v154, s31, -v193
    v_add_u32 v169, s28, v169
    v_mfma_f32_16x16x32_bf16 v[24:27], a[180:183], v[136:139], v[24:27]
    s_waitcnt lgkmcnt(0)
    v_exp_f32 v154, v154
    v_mfma_f32_16x16x32_bf16 v[28:31], a[184:187], v[128:131], v[28:31]
    v_fma_f32 v155, v155, s31, -v193
    v_cvt_pk_bf16_f32 v152, v152, v153
    v_mfma_f32_16x16x32_bf16 v[28:31], a[188:191], v[136:139], v[28:31]
    v_exp_f32 v155, v155
    v_mfma_f32_16x16x32_bf16 a[192:195], a[208:211], v[128:131], a[192:195]
    v_fma_f32 v156, v156, s31, -v193
    v_cvt_pk_bf16_f32 v153, v154, v155
    v_mfma_f32_16x16x32_bf16 a[192:195], a[208:211], v[136:139], a[192:195]
    v_exp_f32 v156, v156
    v_mfma_f32_16x16x32_bf16 v[128:131], a[64:67], a[32:35], 0
    v_fma_f32 v157, v157, s31, -v193
    v_add_u32 v163, s28, v163
    v_mfma_f32_16x16x32_bf16 v[128:131], a[68:71], a[36:39], v[128:131]
    v_exp_f32 v157, v157
    v_mfma_f32_16x16x32_bf16 v[128:131], a[72:75], a[40:43], v[128:131]
    v_fma_f32 v158, v158, s31, -v193
    v_add_u32 v171, s28, v171
    v_mfma_f32_16x16x32_bf16 v[128:131], a[76:79], a[44:47], v[128:131]
    v_exp_f32 v158, v158
    v_mfma_f32_16x16x32_bf16 v[132:135], a[80:83], a[32:35], 0
    v_fma_f32 v159, v159, s31, -v193
    v_cvt_pk_bf16_f32 v154, v156, v157
    v_mfma_f32_16x16x32_bf16 v[132:135], a[84:87], a[36:39], v[132:135]
    v_exp_f32 v159, v159
    v_mfma_f32_16x16x32_bf16 v[132:135], a[88:91], a[40:43], v[132:135]
    s_add_u32 m0, s34, 12288
    v_add_u32 v160, s28, v160
    v_mfma_f32_16x16x32_bf16 v[132:135], a[92:95], a[44:47], v[132:135]
    buffer_load_dwordx4 v185, s[16:19], s38 offen offset:1024 nt lds
    v_mfma_f32_16x16x32_bf16 v[136:139], a[96:99], a[32:35], 0
    v_fma_f32 v128, v128, s31, -v194
    v_cvt_pk_bf16_f32 v155, v158, v159
    v_mfma_f32_16x16x32_bf16 v[136:139], a[100:103], a[36:39], v[136:139]
    v_exp_f32 v128, v128
    v_mfma_f32_16x16x32_bf16 v[136:139], a[104:107], a[40:43], v[136:139]
    v_fma_f32 v129, v129, s31, -v194
    v_add_u32 v168, s28, v168
    v_mfma_f32_16x16x32_bf16 v[136:139], a[108:111], a[44:47], v[136:139]
    v_exp_f32 v129, v129
    v_mfma_f32_16x16x32_bf16 v[140:143], a[112:115], a[32:35], 0
    v_fma_f32 v130, v130, s31, -v194
    v_cvt_pk_bf16_f32 v128, v128, v129
    v_mfma_f32_16x16x32_bf16 v[140:143], a[116:119], a[36:39], v[140:143]
    v_exp_f32 v130, v130
    v_mfma_f32_16x16x32_bf16 v[140:143], a[120:123], a[40:43], v[140:143]
    v_fma_f32 v131, v131, s31, -v194
    v_add_u32 v161, s28, v161
    v_mfma_f32_16x16x32_bf16 v[140:143], a[124:127], a[44:47], v[140:143]
    v_exp_f32 v131, v131
    v_mfma_f32_16x16x32_bf16 v[32:35], a[128:131], v[144:147], v[32:35]
    v_fma_f32 v132, v132, s31, -v194
    v_cvt_pk_bf16_f32 v129, v130, v131
    v_mfma_f32_16x16x32_bf16 v[32:35], a[132:135], v[152:155], v[32:35]
    v_exp_f32 v132, v132
    v_mfma_f32_16x16x32_bf16 v[36:39], a[136:139], v[144:147], v[36:39]
    v_fma_f32 v133, v133, s31, -v194
    v_add_u32 v162, s28, v162
    v_mfma_f32_16x16x32_bf16 v[36:39], a[140:143], v[152:155], v[36:39]
    v_exp_f32 v133, v133
    v_mfma_f32_16x16x32_bf16 v[40:43], a[144:147], v[144:147], v[40:43]
    v_fma_f32 v134, v134, s31, -v194
    v_cvt_pk_bf16_f32 v130, v132, v133
    v_mfma_f32_16x16x32_bf16 v[40:43], a[148:151], v[152:155], v[40:43]
    s_add_u32 m0, s34, 12288
    v_exp_f32 v134, v134
    v_mfma_f32_16x16x32_bf16 v[44:47], a[152:155], v[144:147], v[44:47]
    buffer_load_dwordx4 v186, s[16:19], s38 offen offset:2048 nt lds
    v_fma_f32 v135, v135, s31, -v194
    v_mfma_f32_16x16x32_bf16 v[44:47], a[156:159], v[152:155], v[44:47]
    s_add_u32 m0, s34, 12288
    v_exp_f32 v135, v135
    v_mfma_f32_16x16x32_bf16 v[48:51], a[160:163], v[144:147], v[48:51]
    buffer_load_dwordx4 v187, s[16:19], s38 offen offset:3072 nt lds
    v_fma_f32 v136, v136, s31, -v194
    v_mfma_f32_16x16x32_bf16 v[48:51], a[164:167], v[152:155], v[48:51]
    v_exp_f32 v136, v136
    v_mfma_f32_16x16x32_bf16 v[52:55], a[168:171], v[144:147], v[52:55]
    v_fma_f32 v137, v137, s31, -v194
    v_cvt_pk_bf16_f32 v131, v134, v135
    v_mfma_f32_16x16x32_bf16 v[52:55], a[172:175], v[152:155], v[52:55]
    v_exp_f32 v137, v137
    v_mfma_f32_16x16x32_bf16 v[56:59], a[176:179], v[144:147], v[56:59]
    v_fma_f32 v138, v138, s31, -v194
    v_cvt_pk_bf16_f32 v136, v136, v137
    v_mfma_f32_16x16x32_bf16 v[56:59], a[180:183], v[152:155], v[56:59]
    v_exp_f32 v138, v138
    v_mfma_f32_16x16x32_bf16 v[60:63], a[184:187], v[144:147], v[60:63]
    v_fma_f32 v139, v139, s31, -v194
    v_add_u32 v170, s28, v170
    v_mfma_f32_16x16x32_bf16 v[60:63], a[188:191], v[152:155], v[60:63]
    v_exp_f32 v139, v139
    v_mfma_f32_16x16x32_bf16 a[196:199], a[208:211], v[144:147], a[196:199]
    s_add_u32 s27, s27, s28
    v_fma_f32 v140, v140, s31, -v194
    v_cvt_pk_bf16_f32 v137, v138, v139
    v_mfma_f32_16x16x32_bf16 a[196:199], a[208:211], v[152:155], a[196:199]
    v_exp_f32 v140, v140
    v_mfma_f32_16x16x32_bf16 v[144:147], a[64:67], a[48:51], 0
    v_fma_f32 v141, v141, s31, -v194
    s_waitcnt vmcnt(17)
    s_barrier
    v_mfma_f32_16x16x32_bf16 v[144:147], a[68:71], a[52:55], v[144:147]
    v_exp_f32 v141, v141
    v_mfma_f32_16x16x32_bf16 v[144:147], a[72:75], a[56:59], v[144:147]
    ds_read_b128 a[64:67], v160
    ds_read_b128 a[68:71], v161
    v_fma_f32 v142, v142, s31, -v194
    v_mfma_f32_16x16x32_bf16 v[144:147], a[76:79], a[60:63], v[144:147]
    s_mov_b32 m0, s29
    v_exp_f32 v142, v142
    v_cvt_pk_bf16_f32 v138, v140, v141
    v_mfma_f32_16x16x32_bf16 v[148:151], a[80:83], a[48:51], 0
    buffer_load_dwordx4 v184, s[8:11], s25 offen nt lds
    v_fma_f32 v143, v143, s31, -v194
    v_mfma_f32_16x16x32_bf16 v[148:151], a[84:87], a[52:55], v[148:151]
    ds_read_b128 a[72:75], v162
    v_exp_f32 v143, v143
    v_mfma_f32_16x16x32_bf16 v[148:151], a[88:91], a[56:59], v[148:151]
    buffer_load_dwordx4 v185, s[8:11], s25 offen offset:1024 nt lds
    v_mfma_f32_16x16x32_bf16 v[148:151], a[92:95], a[60:63], v[148:151]
    buffer_load_dwordx4 v186, s[8:11], s25 offen offset:2048 nt lds
    v_mfma_f32_16x16x32_bf16 v[152:155], a[96:99], a[48:51], 0
    buffer_load_dwordx4 v187, s[8:11], s25 offen offset:3072 nt lds
    v_fma_f32 v144, v144, s31, -v195
    v_mfma_f32_16x16x32_bf16 v[152:155], a[100:103], a[52:55], v[152:155]
    v_exp_f32 v144, v144
    v_cvt_pk_bf16_f32 v139, v142, v143
    v_mfma_f32_16x16x32_bf16 v[152:155], a[104:107], a[56:59], v[152:155]
    ds_read_b128 a[76:79], v163
    ds_read_b128 a[80:83], v160 offset:4096
    v_fma_f32 v145, v145, s31, -v195
    v_mfma_f32_16x16x32_bf16 v[152:155], a[108:111], a[60:63], v[152:155]
    v_exp_f32 v145, v145
    v_mfma_f32_16x16x32_bf16 v[156:159], a[112:115], a[48:51], 0
    ds_read_b128 a[84:87], v161 offset:4096
    v_fma_f32 v146, v146, s31, -v195
    v_cvt_pk_bf16_f32 v144, v144, v145
    v_mfma_f32_16x16x32_bf16 v[156:159], a[116:119], a[52:55], v[156:159]
    s_add_u32 m0, s29, 49152
    v_exp_f32 v146, v146
    v_mfma_f32_16x16x32_bf16 v[156:159], a[120:123], a[56:59], v[156:159]
    buffer_load_dwordx4 v188, s[12:15], s25 offen nt lds
    v_fma_f32 v147, v147, s31, -v195
    v_mfma_f32_16x16x32_bf16 v[156:159], a[124:127], a[60:63], v[156:159]
    buffer_load_dwordx4 v188, s[12:15], s25 offen offset:1024 nt lds
    v_exp_f32 v147, v147
    v_mfma_f32_16x16x32_bf16 v[64:67], a[128:131], v[128:131], v[64:67]
    ds_read_b128 a[88:91], v162 offset:4096
    v_fma_f32 v148, v148, s31, -v195
    v_cvt_pk_bf16_f32 v145, v146, v147
    v_mfma_f32_16x16x32_bf16 v[64:67], a[132:135], v[136:139], v[64:67]
    ds_read_b128 a[92:95], v163 offset:4096
    v_exp_f32 v148, v148
    v_mfma_f32_16x16x32_bf16 v[68:71], a[136:139], v[128:131], v[68:71]
    ds_read_b128 a[96:99], v160 offset:8192
    v_fma_f32 v149, v149, s31, -v195
    v_mfma_f32_16x16x32_bf16 v[68:71], a[140:143], v[136:139], v[68:71]
    v_exp_f32 v149, v149
    v_mfma_f32_16x16x32_bf16 v[72:75], a[144:147], v[128:131], v[72:75]
    v_fma_f32 v150, v150, s31, -v195
    v_cvt_pk_bf16_f32 v146, v148, v149
    v_mfma_f32_16x16x32_bf16 v[72:75], a[148:151], v[136:139], v[72:75]
    v_exp_f32 v150, v150
    v_mfma_f32_16x16x32_bf16 v[76:79], a[152:155], v[128:131], v[76:79]
    buffer_load_dwordx4 v188, s[12:15], s25 offen offset:2048 nt lds
    v_fma_f32 v151, v151, s31, -v195
    v_mfma_f32_16x16x32_bf16 v[76:79], a[156:159], v[136:139], v[76:79]
    ds_read_b128 a[100:103], v161 offset:8192
    v_exp_f32 v151, v151
    v_mfma_f32_16x16x32_bf16 v[80:83], a[160:163], v[128:131], v[80:83]
    buffer_load_dwordx4 v188, s[12:15], s25 offen offset:3072 nt lds
    v_fma_f32 v152, v152, s31, -v195
    v_cvt_pk_bf16_f32 v147, v150, v151
    v_mfma_f32_16x16x32_bf16 v[80:83], a[164:167], v[136:139], v[80:83]
    v_exp_f32 v152, v152
    v_mfma_f32_16x16x32_bf16 v[84:87], a[168:171], v[128:131], v[84:87]
    ds_read_b128 a[104:107], v162 offset:8192
    ds_read_b128 a[108:111], v163 offset:8192
    v_fma_f32 v153, v153, s31, -v195
    v_mfma_f32_16x16x32_bf16 v[84:87], a[172:175], v[136:139], v[84:87]
    v_exp_f32 v153, v153
    v_mfma_f32_16x16x32_bf16 v[88:91], a[176:179], v[128:131], v[88:91]
    ds_read_b128 a[112:115], v160 offset:12288
    v_fma_f32 v154, v154, s31, -v195
    v_cvt_pk_bf16_f32 v152, v152, v153
    v_mfma_f32_16x16x32_bf16 v[88:91], a[180:183], v[136:139], v[88:91]
    v_exp_f32 v154, v154
    v_mfma_f32_16x16x32_bf16 v[92:95], a[184:187], v[128:131], v[92:95]
    ds_read_b128 a[116:119], v161 offset:12288
    v_fma_f32 v155, v155, s31, -v195
    v_mfma_f32_16x16x32_bf16 v[92:95], a[188:191], v[136:139], v[92:95]
    ds_read_b128 a[120:123], v162 offset:12288
    v_exp_f32 v155, v155
    v_mfma_f32_16x16x32_bf16 a[200:203], a[208:211], v[128:131], a[200:203]
    ds_read_b128 a[124:127], v163 offset:12288
    v_fma_f32 v156, v156, s31, -v195
    v_cvt_pk_bf16_f32 v153, v154, v155
    v_mfma_f32_16x16x32_bf16 a[200:203], a[208:211], v[136:139], a[200:203]
    s_waitcnt lgkmcnt(12)
    v_exp_f32 v156, v156
    s_cmp_eq_u32 s30, 3
    s_cbranch_scc1 L_last
    v_mfma_f32_16x16x32_bf16 v[128:131], a[64:67], a[0:3], 0
    v_fma_f32 v157, v157, s31, -v195
    v_mfma_f32_16x16x32_bf16 v[128:131], a[68:71], a[4:7], v[128:131]
    s_add_u32 s4, s4, 16384
    v_exp_f32 v157, v157
    v_mfma_f32_16x16x32_bf16 v[128:131], a[72:75], a[8:11], v[128:131]
    s_and_b32 s4, s4, 0x1ffff
    v_fma_f32 v158, v158, s31, -v195
    v_cvt_pk_bf16_f32 v154, v156, v157
    v_mfma_f32_16x16x32_bf16 v[128:131], a[76:79], a[12:15], v[128:131]
    s_waitcnt lgkmcnt(8)
    v_exp_f32 v158, v158
    v_mfma_f32_16x16x32_bf16 v[132:135], a[80:83], a[0:3], 0
    v_fma_f32 v159, v159, s31, -v195
    v_mfma_f32_16x16x32_bf16 v[132:135], a[84:87], a[4:7], v[132:135]
    s_add_u32 s25, s3, s4
    v_exp_f32 v159, v159
    v_mfma_f32_16x16x32_bf16 v[132:135], a[88:91], a[8:11], v[132:135]
    v_mfma_f32_16x16x32_bf16 v[132:135], a[92:95], a[12:15], v[132:135]
    s_waitcnt lgkmcnt(4)
    v_mfma_f32_16x16x32_bf16 v[136:139], a[96:99], a[0:3], 0
    v_fma_f32 v128, v128, s31, -v192
    v_cvt_pk_bf16_f32 v155, v158, v159
    v_mfma_f32_16x16x32_bf16 v[136:139], a[100:103], a[4:7], v[136:139]
    s_add_u32 s39, s27, 16384
    v_exp_f32 v128, v128
    v_mfma_f32_16x16x32_bf16 v[136:139], a[104:107], a[8:11], v[136:139]
    v_fma_f32 v129, v129, s31, -v192
    v_mfma_f32_16x16x32_bf16 v[136:139], a[108:111], a[12:15], v[136:139]
    s_waitcnt lgkmcnt(0)
    v_exp_f32 v129, v129
    v_mfma_f32_16x16x32_bf16 v[140:143], a[112:115], a[0:3], 0
    v_fma_f32 v130, v130, s31, -v192
    v_cvt_pk_bf16_f32 v128, v128, v129
    v_mfma_f32_16x16x32_bf16 v[140:143], a[116:119], a[4:7], v[140:143]
    s_cmp_eq_u32 s39, 49152
    s_cselect_b32 s39, 0, s39
    v_exp_f32 v130, v130
    v_mfma_f32_16x16x32_bf16 v[140:143], a[120:123], a[8:11], v[140:143]
    s_sub_u32 s28, s39, s27
    v_fma_f32 v131, v131, s31, -v192
    v_mfma_f32_16x16x32_bf16 v[140:143], a[124:127], a[12:15], v[140:143]
    v_exp_f32 v131, v131
    v_mfma_f32_16x16x32_bf16 v[96:99], a[128:131], v[144:147], v[96:99]
    v_fma_f32 v132, v132, s31, -v192
    v_cvt_pk_bf16_f32 v129, v130, v131
    v_mfma_f32_16x16x32_bf16 v[96:99], a[132:135], v[152:155], v[96:99]
    v_exp_f32 v132, v132
    v_mfma_f32_16x16x32_bf16 v[100:103], a[136:139], v[144:147], v[100:103]
    ds_read_b128 a[0:3], v164
    v_fma_f32 v133, v133, s31, -v192
    v_mfma_f32_16x16x32_bf16 v[100:103], a[140:143], v[152:155], v[100:103]
    v_exp_f32 v133, v133
    v_mfma_f32_16x16x32_bf16 v[104:107], a[144:147], v[144:147], v[104:107]
    s_add_u32 s29, s27, s50
    ds_read_b64_tr_b16 a[128:129], v168
    v_fma_f32 v134, v134, s31, -v192
    v_mfma_f32_16x16x32_bf16 v[104:107], a[148:151], v[152:155], v[104:107]
    v_exp_f32 v134, v134
    v_cvt_pk_bf16_f32 v130, v132, v133
    v_mfma_f32_16x16x32_bf16 v[108:111], a[152:155], v[144:147], v[108:111]
    ds_read_b128 a[4:7], v165
    ds_read_b128 a[8:11], v166
    v_fma_f32 v135, v135, s31, -v192
    v_mfma_f32_16x16x32_bf16 v[108:111], a[156:159], v[152:155], v[108:111]
    ds_read_b64_tr_b16 a[130:131], v168 offset:4096
    v_exp_f32 v135, v135
    v_mfma_f32_16x16x32_bf16 v[112:115], a[160:163], v[144:147], v[112:115]
    ds_read_b64_tr_b16 a[132:133], v168 offset:8192
    ds_read_b64_tr_b16 a[134:135], v168 offset:12288
    v_fma_f32 v136, v136, s31, -v192
    v_mfma_f32_16x16x32_bf16 v[112:115], a[164:167], v[152:155], v[112:115]
    ds_read_b64_tr_b16 a[136:137], v168 offset:8
    v_exp_f32 v136, v136
    v_mfma_f32_16x16x32_bf16 v[116:119], a[168:171], v[144:147], v[116:119]
    buffer_store_dwordx4 a[232:235], v185, s[20:23], s38 offen offset:1024 sc1 nt
    v_fma_f32 v137, v137, s31, -v192
    v_mfma_f32_16x16x32_bf16 v[116:119], a[172:175], v[152:155], v[116:119]
    v_exp_f32 v137, v137
    v_cvt_pk_bf16_f32 v131, v134, v135
    v_mfma_f32_16x16x32_bf16 v[120:123], a[176:179], v[144:147], v[120:123]
    v_fma_f32 v138, v138, s31, -v192
    v_cvt_pk_bf16_f32 v136, v136, v137
    v_mfma_f32_16x16x32_bf16 v[120:123], a[180:183], v[152:155], v[120:123]
    ds_read_b64_tr_b16 a[138:139], v168 offset:4104
    v_exp_f32 v138, v138
    v_mfma_f32_16x16x32_bf16 v[124:127], a[184:187], v[144:147], v[124:127]
    ds_read_b64_tr_b16 a[140:141], v168 offset:8200
    ds_read_b64_tr_b16 a[142:143], v168 offset:12296
    v_fma_f32 v139, v139, s31, -v192
    v_mfma_f32_16x16x32_bf16 v[124:127], a[188:191], v[152:155], v[124:127]
    v_exp_f32 v139, v139
    v_mfma_f32_16x16x32_bf16 a[204:207], a[208:211], v[144:147], a[204:207]
    ds_read_b64_tr_b16 a[144:145], v169
    ds_read_b64_tr_b16 a[146:147], v169 offset:4096
    v_fma_f32 v140, v140, s31, -v192
    v_mfma_f32_16x16x32_bf16 a[204:207], a[208:211], v[152:155], a[204:207]
    v_exp_f32 v140, v140
    v_cvt_pk_bf16_f32 v137, v138, v139
    v_mfma_f32_16x16x32_bf16 v[144:147], a[64:67], a[16:19], 0
    ds_read_b64_tr_b16 a[148:149], v169 offset:8192
    ds_read_b64_tr_b16 a[150:151], v169 offset:12288
    v_fma_f32 v141, v141, s31, -v192
    v_mfma_f32_16x16x32_bf16 v[144:147], a[68:71], a[20:23], v[144:147]
    ds_read_b64_tr_b16 a[152:153], v169 offset:8
    ds_read_b64_tr_b16 a[154:155], v169 offset:4104
    v_exp_f32 v141, v141
    v_mfma_f32_16x16x32_bf16 v[144:147], a[72:75], a[24:27], v[144:147]
    ds_read_b128 a[12:15], v167
    v_fma_f32 v142, v142, s31, -v192
    v_mfma_f32_16x16x32_bf16 v[144:147], a[76:79], a[28:31], v[144:147]
    v_exp_f32 v142, v142
    v_mfma_f32_16x16x32_bf16 v[148:151], a[80:83], a[16:19], 0
    ds_read_b64_tr_b16 a[156:157], v169 offset:8200
    v_fma_f32 v143, v143, s31, -v192
    v_cvt_pk_bf16_f32 v138, v140, v141
    v_mfma_f32_16x16x32_bf16 v[148:151], a[84:87], a[20:23], v[148:151]
    ds_read_b64_tr_b16 a[158:159], v169 offset:12296
    v_exp_f32 v143, v143
    v_mfma_f32_16x16x32_bf16 v[148:151], a[88:91], a[24:27], v[148:151]
    ds_read_b64_tr_b16 a[160:161], v170
    v_cvt_pk_bf16_f32 v139, v142, v143
    v_mfma_f32_16x16x32_bf16 v[148:151], a[92:95], a[28:31], v[148:151]
    ds_read_b64_tr_b16 a[162:163], v170 offset:4096
    ds_read_b64_tr_b16 a[164:165], v170 offset:8192
    v_mfma_f32_16x16x32_bf16 v[152:155], a[96:99], a[16:19], 0
    ds_read_b64_tr_b16 a[166:167], v170 offset:12288
    v_fma_f32 v144, v144, s31, -v193
    v_mfma_f32_16x16x32_bf16 v[152:155], a[100:103], a[20:23], v[152:155]
    v_exp_f32 v144, v144
    v_mfma_f32_16x16x32_bf16 v[152:155], a[104:107], a[24:27], v[152:155]
    ds_read_b64_tr_b16 a[168:169], v170 offset:8
    v_fma_f32 v145, v145, s31, -v193
    v_mfma_f32_16x16x32_bf16 v[152:155], a[108:111], a[28:31], v[152:155]
    v_exp_f32 v145, v145
    v_mfma_f32_16x16x32_bf16 v[156:159], a[112:115], a[16:19], 0
    ds_read_b64_tr_b16 a[170:171], v170 offset:4104
    ds_read_b64_tr_b16 a[172:173], v170 offset:8200
    v_fma_f32 v146, v146, s31, -v193
    v_cvt_pk_bf16_f32 v144, v144, v145
    v_mfma_f32_16x16x32_bf16 v[156:159], a[116:119], a[20:23], v[156:159]
    ds_read_b64_tr_b16 a[174:175], v170 offset:12296
    v_exp_f32 v146, v146
    v_mfma_f32_16x16x32_bf16 v[156:159], a[120:123], a[24:27], v[156:159]
    ds_read_b64_tr_b16 a[176:177], v171
    v_fma_f32 v147, v147, s31, -v193
    v_mfma_f32_16x16x32_bf16 v[156:159], a[124:127], a[28:31], v[156:159]
    s_waitcnt lgkmcnt(15)
    v_exp_f32 v147, v147
    v_mfma_f32_16x16x32_bf16 v[0:3], a[128:131], v[128:131], v[0:3]
    v_fma_f32 v148, v148, s31, -v193
    v_cvt_pk_bf16_f32 v145, v146, v147
    v_mfma_f32_16x16x32_bf16 v[0:3], a[132:135], v[136:139], v[0:3]
    ds_read_b64_tr_b16 a[178:179], v171 offset:4096
    v_exp_f32 v148, v148
    v_mfma_f32_16x16x32_bf16 v[4:7], a[136:139], v[128:131], v[4:7]
    ds_read_b64_tr_b16 a[180:181], v171 offset:8192
    v_fma_f32 v149, v149, s31, -v193
    v_mfma_f32_16x16x32_bf16 v[4:7], a[140:143], v[136:139], v[4:7]
    s_waitcnt lgkmcnt(15)
    v_exp_f32 v149, v149
    v_mfma_f32_16x16x32_bf16 v[8:11], a[144:147], v[128:131], v[8:11]
    ds_read_b64_tr_b16 a[182:183], v171 offset:12288
    v_fma_f32 v150, v150, s31, -v193
    v_mfma_f32_16x16x32_bf16 v[8:11], a[148:151], v[136:139], v[8:11]
    s_waitcnt lgkmcnt(12)
    v_exp_f32 v150, v150
    v_cvt_pk_bf16_f32 v146, v148, v149
    v_mfma_f32_16x16x32_bf16 v[12:15], a[152:155], v[128:131], v[12:15]
    ds_read_b128 a[16:19], v164 offset:4096
    v_fma_f32 v151, v151, s31, -v193
    v_mfma_f32_16x16x32_bf16 v[12:15], a[156:159], v[136:139], v[12:15]
    s_waitcnt lgkmcnt(9)
    ds_read_b64_tr_b16 a[184:185], v171 offset:8
    v_exp_f32 v151, v151
    v_mfma_f32_16x16x32_bf16 v[16:19], a[160:163], v[128:131], v[16:19]
    ds_read_b64_tr_b16 a[186:187], v171 offset:4104
    ds_read_b64_tr_b16 a[188:189], v171 offset:8200
    v_fma_f32 v152, v152, s31, -v193
    v_mfma_f32_16x16x32_bf16 v[16:19], a[164:167], v[136:139], v[16:19]
    s_waitcnt lgkmcnt(8)
    ds_read_b64_tr_b16 a[190:191], v171 offset:12296
    v_exp_f32 v152, v152
    v_mfma_f32_16x16x32_bf16 v[20:23], a[168:171], v[128:131], v[20:23]
    v_fma_f32 v153, v153, s31, -v193
    v_cvt_pk_bf16_f32 v147, v150, v151
    v_mfma_f32_16x16x32_bf16 v[20:23], a[172:175], v[136:139], v[20:23]
    s_waitcnt lgkmcnt(5)
    ds_read_b128 a[20:23], v165 offset:4096
    v_exp_f32 v153, v153
    v_mfma_f32_16x16x32_bf16 v[24:27], a[176:179], v[128:131], v[24:27]
    ds_read_b128 a[24:27], v166 offset:4096
    v_fma_f32 v154, v154, s31, -v193
    v_mfma_f32_16x16x32_bf16 v[24:27], a[180:183], v[136:139], v[24:27]
    s_waitcnt lgkmcnt(2)
    v_exp_f32 v154, v154
    v_mfma_f32_16x16x32_bf16 v[28:31], a[184:187], v[128:131], v[28:31]
    v_fma_f32 v155, v155, s31, -v193
    v_cvt_pk_bf16_f32 v152, v152, v153
    v_mfma_f32_16x16x32_bf16 v[28:31], a[188:191], v[136:139], v[28:31]
    v_exp_f32 v155, v155
    v_mfma_f32_16x16x32_bf16 a[192:195], a[208:211], v[128:131], a[192:195]
    buffer_store_dwordx4 a[236:239], v186, s[20:23], s38 offen offset:2048 sc1 nt
    v_fma_f32 v156, v156, s31, -v193
    v_mfma_f32_16x16x32_bf16 a[192:195], a[208:211], v[136:139], a[192:195]
    v_exp_f32 v156, v156
    v_mfma_f32_16x16x32_bf16 v[128:131], a[64:67], a[32:35], 0
    v_fma_f32 v157, v157, s31, -v193
    v_cvt_pk_bf16_f32 v153, v154, v155
    v_mfma_f32_16x16x32_bf16 v[128:131], a[68:71], a[36:39], v[128:131]
    v_exp_f32 v157, v157
    v_mfma_f32_16x16x32_bf16 v[128:131], a[72:75], a[40:43], v[128:131]
    ds_read_b128 a[28:31], v167 offset:4096
    v_fma_f32 v158, v158, s31, -v193
    v_mfma_f32_16x16x32_bf16 v[128:131], a[76:79], a[44:47], v[128:131]
    v_exp_f32 v158, v158
    v_mfma_f32_16x16x32_bf16 v[132:135], a[80:83], a[32:35], 0
    v_fma_f32 v159, v159, s31, -v193
    v_cvt_pk_bf16_f32 v154, v156, v157
    v_mfma_f32_16x16x32_bf16 v[132:135], a[84:87], a[36:39], v[132:135]
    v_exp_f32 v159, v159
    v_mfma_f32_16x16x32_bf16 v[132:135], a[88:91], a[40:43], v[132:135]
    v_add_u32 v161, s28, v161
    v_add_u32 v163, s28, v163
    v_mfma_f32_16x16x32_bf16 v[132:135], a[92:95], a[44:47], v[132:135]
    v_cvt_pk_bf16_f32 v155, v158, v159
    v_add_u32 v171, s28, v171
    v_mfma_f32_16x16x32_bf16 v[136:139], a[96:99], a[32:35], 0
    v_fma_f32 v128, v128, s31, -v194
    v_add_u32 v169, s28, v169
    v_mfma_f32_16x16x32_bf16 v[136:139], a[100:103], a[36:39], v[136:139]
    v_exp_f32 v128, v128
    v_mfma_f32_16x16x32_bf16 v[136:139], a[104:107], a[40:43], v[136:139]
    v_fma_f32 v129, v129, s31, -v194
    v_add_u32 v170, s28, v170
    v_mfma_f32_16x16x32_bf16 v[136:139], a[108:111], a[44:47], v[136:139]
    v_exp_f32 v129, v129
    v_mfma_f32_16x16x32_bf16 v[140:143], a[112:115], a[32:35], 0
    v_fma_f32 v130, v130, s31, -v194
    v_add_u32 v162, s28, v162
    v_mfma_f32_16x16x32_bf16 v[140:143], a[116:119], a[36:39], v[140:143]
    v_exp_f32 v130, v130
    v_mfma_f32_16x16x32_bf16 v[140:143], a[120:123], a[40:43], v[140:143]
    v_fma_f32 v131, v131, s31, -v194
    v_cvt_pk_bf16_f32 v128, v128, v129
    v_mfma_f32_16x16x32_bf16 v[140:143], a[124:127], a[44:47], v[140:143]
    s_waitcnt vmcnt(24)
    v_exp_f32 v131, v131
    v_mfma_f32_16x16x32_bf16 v[32:35], a[128:131], v[144:147], v[32:35]
    v_fma_f32 v132, v132, s31, -v194
    v_cvt_pk_bf16_f32 v129, v130, v131
    v_mfma_f32_16x16x32_bf16 v[32:35], a[132:135], v[152:155], v[32:35]
    v_exp_f32 v132, v132
    v_mfma_f32_16x16x32_bf16 v[36:39], a[136:139], v[144:147], v[36:39]
    ds_read_b128 a[32:35], v164 offset:8192
    v_fma_f32 v133, v133, s31, -v194
    v_mfma_f32_16x16x32_bf16 v[36:39], a[140:143], v[152:155], v[36:39]
    v_exp_f32 v133, v133
    v_mfma_f32_16x16x32_bf16 v[40:43], a[144:147], v[144:147], v[40:43]
    v_fma_f32 v134, v134, s31, -v194
    v_cvt_pk_bf16_f32 v130, v132, v133
    v_mfma_f32_16x16x32_bf16 v[40:43], a[148:151], v[152:155], v[40:43]
    v_exp_f32 v134, v134
    v_mfma_f32_16x16x32_bf16 v[44:47], a[152:155], v[144:147], v[44:47]
    ds_read_b128 a[36:39], v165 offset:8192
    v_fma_f32 v135, v135, s31, -v194
    v_mfma_f32_16x16x32_bf16 v[44:47], a[156:159], v[152:155], v[44:47]
    v_exp_f32 v135, v135
    v_mfma_f32_16x16x32_bf16 v[48:51], a[160:163], v[144:147], v[48:51]
    v_fma_f32 v136, v136, s31, -v194
    v_add_u32 v160, s28, v160
    v_mfma_f32_16x16x32_bf16 v[48:51], a[164:167], v[152:155], v[48:51]
    v_exp_f32 v136, v136
    v_mfma_f32_16x16x32_bf16 v[52:55], a[168:171], v[144:147], v[52:55]
    v_fma_f32 v137, v137, s31, -v194
    v_cvt_pk_bf16_f32 v131, v134, v135
    v_mfma_f32_16x16x32_bf16 v[52:55], a[172:175], v[152:155], v[52:55]
    v_exp_f32 v137, v137
    v_add_u32 v168, s28, v168
    v_mfma_f32_16x16x32_bf16 v[56:59], a[176:179], v[144:147], v[56:59]
    buffer_store_dwordx4 a[240:243], v187, s[20:23], s38 offen offset:3072 sc1 nt
    v_fma_f32 v138, v138, s31, -v194
    v_mfma_f32_16x16x32_bf16 v[56:59], a[180:183], v[152:155], v[56:59]
    ds_read_b128 a[40:43], v166 offset:8192
    v_exp_f32 v138, v138
    v_mfma_f32_16x16x32_bf16 v[60:63], a[184:187], v[144:147], v[60:63]
    v_fma_f32 v139, v139, s31, -v194
    v_cvt_pk_bf16_f32 v136, v136, v137
    v_mfma_f32_16x16x32_bf16 v[60:63], a[188:191], v[152:155], v[60:63]
    v_exp_f32 v139, v139
    v_mfma_f32_16x16x32_bf16 a[196:199], a[208:211], v[144:147], a[196:199]
    s_add_u32 s27, s27, s28
    v_fma_f32 v140, v140, s31, -v194
    v_cvt_pk_bf16_f32 v137, v138, v139
    v_mfma_f32_16x16x32_bf16 a[196:199], a[208:211], v[152:155], a[196:199]
    v_exp_f32 v140, v140
    v_mfma_f32_16x16x32_bf16 v[144:147], a[64:67], a[48:51], 0
    v_fma_f32 v141, v141, s31, -v194
    s_waitcnt vmcnt(15)
    s_barrier
    v_mfma_f32_16x16x32_bf16 v[144:147], a[68:71], a[52:55], v[144:147]
    v_exp_f32 v141, v141
    v_mfma_f32_16x16x32_bf16 v[144:147], a[72:75], a[56:59], v[144:147]
    ds_read_b128 a[64:67], v160
    ds_read_b128 a[68:71], v161
    v_fma_f32 v142, v142, s31, -v194
    v_mfma_f32_16x16x32_bf16 v[144:147], a[76:79], a[60:63], v[144:147]
    v_exp_f32 v142, v142
    v_mfma_f32_16x16x32_bf16 v[148:151], a[80:83], a[48:51], 0
    ds_read_b128 a[44:47], v167 offset:8192
    v_fma_f32 v143, v143, s31, -v194
    v_mfma_f32_16x16x32_bf16 v[148:151], a[84:87], a[52:55], v[148:151]
    s_mov_b32 m0, s29
    v_exp_f32 v143, v143
    v_cvt_pk_bf16_f32 v138, v140, v141
    v_mfma_f32_16x16x32_bf16 v[148:151], a[88:91], a[56:59], v[148:151]
    ds_read_b128 a[72:75], v162
    buffer_load_dwordx4 v184, s[8:11], s25 offen nt lds
    v_mfma_f32_16x16x32_bf16 v[148:151], a[92:95], a[60:63], v[148:151]
    buffer_load_dwordx4 v185, s[8:11], s25 offen offset:1024 nt lds
    v_cvt_pk_bf16_f32 v139, v142, v143
    v_mfma_f32_16x16x32_bf16 v[152:155], a[96:99], a[48:51], 0
    ds_read_b128 a[76:79], v163
    ds_read_b128 a[80:83], v160 offset:4096
    v_fma_f32 v144, v144, s31, -v195
    v_mfma_f32_16x16x32_bf16 v[152:155], a[100:103], a[52:55], v[152:155]
    buffer_load_dwordx4 v186, s[8:11], s25 offen offset:2048 nt lds
    v_exp_f32 v144, v144
    v_mfma_f32_16x16x32_bf16 v[152:155], a[104:107], a[56:59], v[152:155]
    buffer_load_dwordx4 v187, s[8:11], s25 offen offset:3072 nt lds
    v_fma_f32 v145, v145, s31, -v195
    v_mfma_f32_16x16x32_bf16 v[152:155], a[108:111], a[60:63], v[152:155]
    ds_read_b128 a[84:87], v161 offset:4096
    v_exp_f32 v145, v145
    v_mfma_f32_16x16x32_bf16 v[156:159], a[112:115], a[48:51], 0
    v_fma_f32 v146, v146, s31, -v195
    v_cvt_pk_bf16_f32 v144, v144, v145
    v_mfma_f32_16x16x32_bf16 v[156:159], a[116:119], a[52:55], v[156:159]
    v_exp_f32 v146, v146
    v_mfma_f32_16x16x32_bf16 v[156:159], a[120:123], a[56:59], v[156:159]
    ds_read_b128 a[88:91], v162 offset:4096
    v_fma_f32 v147, v147, s31, -v195
    v_mfma_f32_16x16x32_bf16 v[156:159], a[124:127], a[60:63], v[156:159]
    s_waitcnt vmcnt(15)
    v_exp_f32 v147, v147
    v_mfma_f32_16x16x32_bf16 v[64:67], a[128:131], v[128:131], v[64:67]
    ds_read_b128 a[48:51], v164 offset:12288
    v_fma_f32 v148, v148, s31, -v195
    v_cvt_pk_bf16_f32 v145, v146, v147
    v_mfma_f32_16x16x32_bf16 v[64:67], a[132:135], v[136:139], v[64:67]
    s_add_u32 m0, s29, 49152
    ds_read_b128 a[92:95], v163 offset:4096
    ds_read_b128 a[96:99], v160 offset:8192
    v_exp_f32 v148, v148
    v_mfma_f32_16x16x32_bf16 v[68:71], a[136:139], v[128:131], v[68:71]
    buffer_load_dwordx4 v188, s[12:15], s25 offen nt lds
    v_fma_f32 v149, v149, s31, -v195
    v_mfma_f32_16x16x32_bf16 v[68:71], a[140:143], v[136:139], v[68:71]
    ds_read_b128 a[100:103], v161 offset:8192
    v_exp_f32 v149, v149
    v_mfma_f32_16x16x32_bf16 v[72:75], a[144:147], v[128:131], v[72:75]
    ds_read_b128 a[52:55], v165 offset:12288
    v_fma_f32 v150, v150, s31, -v195
    v_cvt_pk_bf16_f32 v146, v148, v149
    v_mfma_f32_16x16x32_bf16 v[72:75], a[148:151], v[136:139], v[72:75]
    ds_read_b128 a[56:59], v166 offset:12288
    v_exp_f32 v150, v150
    v_mfma_f32_16x16x32_bf16 v[76:79], a[152:155], v[128:131], v[76:79]
    buffer_load_dwordx4 v188, s[12:15], s25 offen offset:1024 nt lds
    v_fma_f32 v151, v151, s31, -v195
    v_mfma_f32_16x16x32_bf16 v[76:79], a[156:159], v[136:139], v[76:79]
    buffer_load_dwordx4 v188, s[12:15], s25 offen offset:2048 nt lds
    v_exp_f32 v151, v151
    v_mfma_f32_16x16x32_bf16 v[80:83], a[160:163], v[128:131], v[80:83]
    buffer_load_dwordx4 v188, s[12:15], s25 offen offset:3072 nt lds
    v_fma_f32 v152, v152, s31, -v195
    v_cvt_pk_bf16_f32 v147, v150, v151
    v_mfma_f32_16x16x32_bf16 v[80:83], a[164:167], v[136:139], v[80:83]
    v_exp_f32 v152, v152
    v_mfma_f32_16x16x32_bf16 v[84:87], a[168:171], v[128:131], v[84:87]
    ds_read_b128 a[60:63], v167 offset:12288
    v_fma_f32 v153, v153, s31, -v195
    v_mfma_f32_16x16x32_bf16 v[84:87], a[172:175], v[136:139], v[84:87]
    ds_read_b128 a[104:107], v162 offset:8192
    v_exp_f32 v153, v153
    v_mfma_f32_16x16x32_bf16 v[88:91], a[176:179], v[128:131], v[88:91]
    ds_read_b128 a[108:111], v163 offset:8192
    v_fma_f32 v154, v154, s31, -v195
    v_cvt_pk_bf16_f32 v152, v152, v153
    v_mfma_f32_16x16x32_bf16 v[88:91], a[180:183], v[136:139], v[88:91]
    ds_read_b128 a[112:115], v160 offset:12288
    v_exp_f32 v154, v154
    v_mfma_f32_16x16x32_bf16 v[92:95], a[184:187], v[128:131], v[92:95]
    ds_read_b128 a[116:119], v161 offset:12288
    ds_read_b128 a[120:123], v162 offset:12288
    v_fma_f32 v155, v155, s31, -v195
    v_mfma_f32_16x16x32_bf16 v[92:95], a[188:191], v[136:139], v[92:95]
    ds_read_b128 a[124:127], v163 offset:12288
    v_exp_f32 v155, v155
    v_mfma_f32_16x16x32_bf16 a[200:203], a[208:211], v[128:131], a[200:203]
    v_fma_f32 v156, v156, s31, -v195
    v_cvt_pk_bf16_f32 v153, v154, v155
    v_mfma_f32_16x16x32_bf16 a[200:203], a[208:211], v[136:139], a[200:203]
    s_waitcnt lgkmcnt(15)
    v_exp_f32 v156, v156
    s_add_u32 s30, s30, 1
    s_branch L_top
L_last:
    v_mfma_f32_16x16x32_bf16 v[128:131], a[64:67], a[0:3], 0
    v_fma_f32 v157, v157, s31, -v195
    v_mfma_f32_16x16x32_bf16 v[128:131], a[68:71], a[4:7], v[128:131]
    s_add_u32 s4, s4, 16384
    v_exp_f32 v157, v157
    v_mfma_f32_16x16x32_bf16 v[128:131], a[72:75], a[8:11], v[128:131]
    s_and_b32 s4, s4, 0x1ffff
    v_fma_f32 v158, v158, s31, -v195
    v_cvt_pk_bf16_f32 v154, v156, v157
    v_mfma_f32_16x16x32_bf16 v[128:131], a[76:79], a[12:15], v[128:131]
    s_waitcnt lgkmcnt(8)
    v_exp_f32 v158, v158
    v_mfma_f32_16x16x32_bf16 v[132:135], a[80:83], a[0:3], 0
    v_fma_f32 v159, v159, s31, -v195
    v_mfma_f32_16x16x32_bf16 v[132:135], a[84:87], a[4:7], v[132:135]
    s_add_u32 s25, s3, s4
    v_exp_f32 v159, v159
    v_mfma_f32_16x16x32_bf16 v[132:135], a[88:91], a[8:11], v[132:135]
    v_mfma_f32_16x16x32_bf16 v[132:135], a[92:95], a[12:15], v[132:135]
    s_waitcnt lgkmcnt(4)
    buffer_store_dwordx4 a[232:235], v185, s[20:23], s38 offen offset:1024 sc1 nt
    v_mfma_f32_16x16x32_bf16 v[136:139], a[96:99], a[0:3], 0
    v_fma_f32 v128, v128, s31, -v192
    v_cvt_pk_bf16_f32 v155, v158, v159
    v_mfma_f32_16x16x32_bf16 v[136:139], a[100:103], a[4:7], v[136:139]
    v_exp_f32 v128, v128
    v_mfma_f32_16x16x32_bf16 v[136:139], a[104:107], a[8:11], v[136:139]
    buffer_store_dwordx4 a[236:239], v186, s[20:23], s38 offen offset:2048 sc1 nt
    v_fma_f32 v129, v129, s31, -v192
    v_mfma_f32_16x16x32_bf16 v[136:139], a[108:111], a[12:15], v[136:139]
    s_waitcnt lgkmcnt(0)
    v_exp_f32 v129, v129
    v_mfma_f32_16x16x32_bf16 v[140:143], a[112:115], a[0:3], 0
    v_fma_f32 v130, v130, s31, -v192
    v_mfma_f32_16x16x32_bf16 v[140:143], a[116:119], a[4:7], v[140:143]
    v_exp_f32 v130, v130
    v_mfma_f32_16x16x32_bf16 v[140:143], a[120:123], a[8:11], v[140:143]
    v_fma_f32 v131, v131, s31, -v192
    v_cvt_pk_bf16_f32 v128, v128, v129
    v_mfma_f32_16x16x32_bf16 v[140:143], a[124:127], a[12:15], v[140:143]
    v_exp_f32 v131, v131
    v_mfma_f32_16x16x32_bf16 v[96:99], a[128:131], v[144:147], v[96:99]
    v_fma_f32 v132, v132, s31, -v192
    v_cvt_pk_bf16_f32 v129, v130, v131
    v_mfma_f32_16x16x32_bf16 v[96:99], a[132:135], v[152:155], v[96:99]
    ds_read_b64_tr_b16 a[128:129], v168
    v_exp_f32 v132, v132
    v_mfma_f32_16x16x32_bf16 v[100:103], a[136:139], v[144:147], v[100:103]
    ds_read_b64_tr_b16 a[130:131], v168 offset:4096
    ds_read_b64_tr_b16 a[132:133], v168 offset:8192
    v_fma_f32 v133, v133, s31, -v192
    v_mfma_f32_16x16x32_bf16 v[100:103], a[140:143], v[152:155], v[100:103]
    ds_read_b64_tr_b16 a[134:135], v168 offset:12288
    v_exp_f32 v133, v133
    v_mfma_f32_16x16x32_bf16 v[104:107], a[144:147], v[144:147], v[104:107]
    ds_read_b64_tr_b16 a[136:137], v168 offset:8
    ds_read_b64_tr_b16 a[138:139], v168 offset:4104
    ds_read_b64_tr_b16 a[140:141], v168 offset:8200
    v_fma_f32 v134, v134, s31, -v192
    v_mfma_f32_16x16x32_bf16 v[104:107], a[148:151], v[152:155], v[104:107]
    ds_read_b64_tr_b16 a[142:143], v168 offset:12296
    v_exp_f32 v134, v134
    v_mfma_f32_16x16x32_bf16 v[108:111], a[152:155], v[144:147], v[108:111]
    ds_read_b64_tr_b16 a[144:145], v169
    v_fma_f32 v135, v135, s31, -v192
    v_cvt_pk_bf16_f32 v130, v132, v133
    v_mfma_f32_16x16x32_bf16 v[108:111], a[156:159], v[152:155], v[108:111]
    v_exp_f32 v135, v135
    v_mfma_f32_16x16x32_bf16 v[112:115], a[160:163], v[144:147], v[112:115]
    ds_read_b64_tr_b16 a[146:147], v169 offset:4096
    ds_read_b64_tr_b16 a[148:149], v169 offset:8192
    v_fma_f32 v136, v136, s31, -v192
    v_mfma_f32_16x16x32_bf16 v[112:115], a[164:167], v[152:155], v[112:115]
    v_exp_f32 v136, v136
    v_mfma_f32_16x16x32_bf16 v[116:119], a[168:171], v[144:147], v[116:119]
    ds_read_b64_tr_b16 a[150:151], v169 offset:12288
    v_fma_f32 v137, v137, s31, -v192
    v_cvt_pk_bf16_f32 v131, v134, v135
    v_mfma_f32_16x16x32_bf16 v[116:119], a[172:175], v[152:155], v[116:119]
    ds_read_b64_tr_b16 a[152:153], v169 offset:8
    v_exp_f32 v137, v137
    v_mfma_f32_16x16x32_bf16 v[120:123], a[176:179], v[144:147], v[120:123]
    v_fma_f32 v138, v138, s31, -v192
    v_cvt_pk_bf16_f32 v136, v136, v137
    v_mfma_f32_16x16x32_bf16 v[120:123], a[180:183], v[152:155], v[120:123]
    v_exp_f32 v138, v138
    v_mfma_f32_16x16x32_bf16 v[124:127], a[184:187], v[144:147], v[124:127]
    ds_read_b64_tr_b16 a[154:155], v169 offset:4104
    v_fma_f32 v139, v139, s31, -v192
    v_mfma_f32_16x16x32_bf16 v[124:127], a[188:191], v[152:155], v[124:127]
    v_exp_f32 v139, v139
    v_mfma_f32_16x16x32_bf16 a[204:207], a[208:211], v[144:147], a[204:207]
    ds_read_b64_tr_b16 a[156:157], v169 offset:8200
    v_fma_f32 v140, v140, s31, -v192
    v_mfma_f32_16x16x32_bf16 a[204:207], a[208:211], v[152:155], a[204:207]
    v_exp_f32 v140, v140
    v_cvt_pk_bf16_f32 v137, v138, v139
    v_mfma_f32_16x16x32_bf16 v[144:147], a[64:67], a[16:19], 0
    ds_read_b64_tr_b16 a[158:159], v169 offset:12296
    ds_read_b64_tr_b16 a[160:161], v170
    v_fma_f32 v141, v141, s31, -v192
    v_mfma_f32_16x16x32_bf16 v[144:147], a[68:71], a[20:23], v[144:147]
    v_exp_f32 v141, v141
    v_mfma_f32_16x16x32_bf16 v[144:147], a[72:75], a[24:27], v[144:147]
    ds_read_b64_tr_b16 a[162:163], v170 offset:4096
    v_fma_f32 v142, v142, s31, -v192
    v_mfma_f32_16x16x32_bf16 v[144:147], a[76:79], a[28:31], v[144:147]
    v_exp_f32 v142, v142
    v_mfma_f32_16x16x32_bf16 v[148:151], a[80:83], a[16:19], 0
    v_fma_f32 v143, v143, s31, -v192
    v_cvt_pk_bf16_f32 v138, v140, v141
    v_mfma_f32_16x16x32_bf16 v[148:151], a[84:87], a[20:23], v[148:151]
    v_exp_f32 v143, v143
    v_mfma_f32_16x16x32_bf16 v[148:151], a[88:91], a[24:27], v[148:151]
    buffer_store_dwordx4 a[240:243], v187, s[20:23], s38 offen offset:3072 sc1 nt
    v_mfma_f32_16x16x32_bf16 v[148:151], a[92:95], a[28:31], v[148:151]
    ds_read_b64_tr_b16 a[164:165], v170 offset:8192
    ds_read_b64_tr_b16 a[166:167], v170 offset:12288
    ds_read_b64_tr_b16 a[168:169], v170 offset:8
    v_mfma_f32_16x16x32_bf16 v[152:155], a[96:99], a[16:19], 0
    v_fma_f32 v144, v144, s31, -v193
    v_cvt_pk_bf16_f32 v139, v142, v143
    v_mfma_f32_16x16x32_bf16 v[152:155], a[100:103], a[20:23], v[152:155]
    ds_read_b64_tr_b16 a[170:171], v170 offset:4104
    v_exp_f32 v144, v144
    v_mfma_f32_16x16x32_bf16 v[152:155], a[104:107], a[24:27], v[152:155]
    ds_read_b64_tr_b16 a[172:173], v170 offset:8200
    v_fma_f32 v145, v145, s31, -v193
    v_mfma_f32_16x16x32_bf16 v[152:155], a[108:111], a[28:31], v[152:155]
    v_exp_f32 v145, v145
    v_mfma_f32_16x16x32_bf16 v[156:159], a[112:115], a[16:19], 0
    ds_read_b64_tr_b16 a[174:175], v170 offset:12296
    v_fma_f32 v146, v146, s31, -v193
    v_mfma_f32_16x16x32_bf16 v[156:159], a[116:119], a[20:23], v[156:159]
    v_exp_f32 v146, v146
    v_mfma_f32_16x16x32_bf16 v[156:159], a[120:123], a[24:27], v[156:159]
    ds_read_b64_tr_b16 a[176:177], v171
    v_fma_f32 v147, v147, s31, -v193
    v_mfma_f32_16x16x32_bf16 v[156:159], a[124:127], a[28:31], v[156:159]
    s_waitcnt lgkmcnt(15)
    ds_read_b64_tr_b16 a[178:179], v171 offset:4096
    v_exp_f32 v147, v147
    v_cvt_pk_bf16_f32 v144, v144, v145
    v_mfma_f32_16x16x32_bf16 v[0:3], a[128:131], v[128:131], v[0:3]
    v_fma_f32 v148, v148, s31, -v193
    v_cvt_pk_bf16_f32 v145, v146, v147
    v_mfma_f32_16x16x32_bf16 v[0:3], a[132:135], v[136:139], v[0:3]
    ds_read_b64_tr_b16 a[180:181], v171 offset:8192
    v_exp_f32 v148, v148
    v_mfma_f32_16x16x32_bf16 v[4:7], a[136:139], v[128:131], v[4:7]
    ds_read_b64_tr_b16 a[182:183], v171 offset:12288
    v_fma_f32 v149, v149, s31, -v193
    v_mfma_f32_16x16x32_bf16 v[4:7], a[140:143], v[136:139], v[4:7]
    s_waitcnt lgkmcnt(15)
    ds_read_b64_tr_b16 a[184:185], v171 offset:8
    v_exp_f32 v149, v149
    v_mfma_f32_16x16x32_bf16 v[8:11], a[144:147], v[128:131], v[8:11]
    v_fma_f32 v150, v150, s31, -v193
    v_cvt_pk_bf16_f32 v146, v148, v149
    v_mfma_f32_16x16x32_bf16 v[8:11], a[148:151], v[136:139], v[8:11]
    s_waitcnt lgkmcnt(13)
    v_exp_f32 v150, v150
    v_mfma_f32_16x16x32_bf16 v[12:15], a[152:155], v[128:131], v[12:15]
    ds_read_b64_tr_b16 a[186:187], v171 offset:4104
    v_fma_f32 v151, v151, s31, -v193
    v_mfma_f32_16x16x32_bf16 v[12:15], a[156:159], v[136:139], v[12:15]
    s_waitcnt lgkmcnt(10)
    v_exp_f32 v151, v151
    v_mfma_f32_16x16x32_bf16 v[16:19], a[160:163], v[128:131], v[16:19]
    ds_read_b64_tr_b16 a[188:189], v171 offset:8200
    v_fma_f32 v152, v152, s31, -v193
    v_mfma_f32_16x16x32_bf16 v[16:19], a[164:167], v[136:139], v[16:19]
    s_waitcnt lgkmcnt(7)
    ds_read_b64_tr_b16 a[190:191], v171 offset:12296
    v_exp_f32 v152, v152
    v_mfma_f32_16x16x32_bf16 v[20:23], a[168:171], v[128:131], v[20:23]
    v_fma_f32 v153, v153, s31, -v193
    v_cvt_pk_bf16_f32 v147, v150, v151
    v_mfma_f32_16x16x32_bf16 v[20:23], a[172:175], v[136:139], v[20:23]
    s_waitcnt lgkmcnt(4)
    v_exp_f32 v153, v153
    v_mfma_f32_16x16x32_bf16 v[24:27], a[176:179], v[128:131], v[24:27]
    s_add_u32 s20, s20, 2031616
    s_addc_u32 s21, s21, 0
    v_fma_f32 v154, v154, s31, -v193
    v_mfma_f32_16x16x32_bf16 v[24:27], a[180:183], v[136:139], v[24:27]
    s_waitcnt lgkmcnt(0)
    v_exp_f32 v154, v154
    v_mfma_f32_16x16x32_bf16 v[28:31], a[184:187], v[128:131], v[28:31]
    s_mov_b32 s22, 16384
    v_fma_f32 v155, v155, s31, -v193
    v_cvt_pk_bf16_f32 v152, v152, v153
    v_mfma_f32_16x16x32_bf16 v[28:31], a[188:191], v[136:139], v[28:31]
    v_exp_f32 v155, v155
    v_mfma_f32_16x16x32_bf16 a[192:195], a[208:211], v[128:131], a[192:195]
    v_fma_f32 v156, v156, s31, -v193
    v_cvt_pk_bf16_f32 v153, v154, v155
    v_mfma_f32_16x16x32_bf16 a[192:195], a[208:211], v[136:139], a[192:195]
    v_exp_f32 v156, v156
    v_mfma_f32_16x16x32_bf16 v[128:131], a[64:67], a[32:35], 0
    v_fma_f32 v157, v157, s31, -v193
    v_mfma_f32_16x16x32_bf16 v[128:131], a[68:71], a[36:39], v[128:131]
    v_exp_f32 v157, v157
    v_mfma_f32_16x16x32_bf16 v[128:131], a[72:75], a[40:43], v[128:131]
    v_fma_f32 v158, v158, s31, -v193
    v_cvt_pk_bf16_f32 v154, v156, v157
    v_mfma_f32_16x16x32_bf16 v[128:131], a[76:79], a[44:47], v[128:131]
    v_exp_f32 v158, v158
    v_mfma_f32_16x16x32_bf16 v[132:135], a[80:83], a[32:35], 0
    v_fma_f32 v159, v159, s31, -v193
    v_accvgpr_read_b32 v204, a192
    v_mfma_f32_16x16x32_bf16 v[132:135], a[84:87], a[36:39], v[132:135]
    v_exp_f32 v159, v159
    v_mfma_f32_16x16x32_bf16 v[132:135], a[88:91], a[40:43], v[132:135]
    v_rcp_f32 v196, v204
    v_mfma_f32_16x16x32_bf16 v[132:135], a[92:95], a[44:47], v[132:135]
    v_cvt_pk_bf16_f32 v155, v158, v159
    v_mfma_f32_16x16x32_bf16 v[136:139], a[96:99], a[32:35], 0
    v_fma_f32 v128, v128, s31, -v194
    v_mul_f32 v8, v196, v8
    v_mul_f32 v16, v196, v16
    v_mul_f32 v17, v196, v17
    v_mfma_f32_16x16x32_bf16 v[136:139], a[100:103], a[36:39], v[136:139]
    v_exp_f32 v128, v128
    v_mfma_f32_16x16x32_bf16 v[136:139], a[104:107], a[40:43], v[136:139]
    v_fma_f32 v129, v129, s31, -v194
    v_mul_f32 v18, v196, v18
    v_mul_f32 v24, v196, v24
    v_mfma_f32_16x16x32_bf16 v[136:139], a[108:111], a[44:47], v[136:139]
    v_exp_f32 v129, v129
    v_mul_f32 v0, v196, v0
    v_mul_f32 v19, v196, v19
    v_mfma_f32_16x16x32_bf16 v[140:143], a[112:115], a[32:35], 0
    v_fma_f32 v130, v130, s31, -v194
    v_mul_f32 v1, v196, v1
    v_mul_f32 v9, v196, v9
    v_mfma_f32_16x16x32_bf16 v[140:143], a[116:119], a[36:39], v[140:143]
    v_exp_f32 v130, v130
    v_cvt_pk_bf16_f32 v128, v128, v129
    v_mfma_f32_16x16x32_bf16 v[140:143], a[120:123], a[40:43], v[140:143]
    v_fma_f32 v131, v131, s31, -v194
    v_mul_f32 v2, v196, v2
    v_mul_f32 v25, v196, v25
    v_mfma_f32_16x16x32_bf16 v[140:143], a[124:127], a[44:47], v[140:143]
    v_exp_f32 v131, v131
    v_mfma_f32_16x16x32_bf16 v[32:35], a[128:131], v[144:147], v[32:35]
    v_fma_f32 v132, v132, s31, -v194
    v_mul_f32 v3, v196, v3
    v_mul_f32 v26, v196, v26
    v_cvt_pk_bf16_f32 v16, v16, v17
    v_mfma_f32_16x16x32_bf16 v[32:35], a[132:135], v[152:155], v[32:35]
    v_exp_f32 v132, v132
    v_mul_f32 v4, v196, v4
    v_mfma_f32_16x16x32_bf16 v[36:39], a[136:139], v[144:147], v[36:39]
    v_fma_f32 v133, v133, s31, -v194
    v_cvt_pk_bf16_f32 v129, v130, v131
    v_mul_f32 v27, v196, v27
    v_mfma_f32_16x16x32_bf16 v[36:39], a[140:143], v[152:155], v[36:39]
    v_exp_f32 v133, v133
    v_mfma_f32_16x16x32_bf16 v[40:43], a[144:147], v[144:147], v[40:43]
    v_fma_f32 v134, v134, s31, -v194
    v_mul_f32 v10, v196, v10
    v_cvt_pk_bf16_f32 v24, v24, v25
    v_mfma_f32_16x16x32_bf16 v[40:43], a[148:151], v[152:155], v[40:43]
    v_exp_f32 v134, v134
    v_mul_f32 v5, v196, v5
    v_mfma_f32_16x16x32_bf16 v[44:47], a[152:155], v[144:147], v[44:47]
    v_fma_f32 v135, v135, s31, -v194
    v_cvt_pk_bf16_f32 v130, v132, v133
    v_cvt_pk_bf16_f32 v8, v8, v9
    v_mfma_f32_16x16x32_bf16 v[44:47], a[156:159], v[152:155], v[44:47]
    v_exp_f32 v135, v135
    v_mul_f32 v11, v196, v11
    v_mfma_f32_16x16x32_bf16 v[48:51], a[160:163], v[144:147], v[48:51]
    v_fma_f32 v136, v136, s31, -v194
    v_mul_f32 v12, v196, v12
    v_mul_f32 v20, v196, v20
    v_mfma_f32_16x16x32_bf16 v[48:51], a[164:167], v[152:155], v[48:51]
    v_exp_f32 v136, v136
    v_cvt_pk_bf16_f32 v25, v26, v27
    v_mfma_f32_16x16x32_bf16 v[52:55], a[168:171], v[144:147], v[52:55]
    v_fma_f32 v137, v137, s31, -v194
    v_mul_f32 v6, v196, v6
    v_mul_f32 v21, v196, v21
    v_cvt_pk_bf16_f32 v0, v0, v1
    v_mfma_f32_16x16x32_bf16 v[52:55], a[172:175], v[152:155], v[52:55]
    v_exp_f32 v137, v137
    v_cvt_pk_bf16_f32 v131, v134, v135
    v_mfma_f32_16x16x32_bf16 v[56:59], a[176:179], v[144:147], v[56:59]
    v_fma_f32 v138, v138, s31, -v194
    v_mul_f32 v22, v196, v22
    v_mul_f32 v28, v196, v28
    v_mfma_f32_16x16x32_bf16 v[56:59], a[180:183], v[152:155], v[56:59]
    v_exp_f32 v138, v138
    v_cvt_pk_bf16_f32 v136, v136, v137
    v_mfma_f32_16x16x32_bf16 v[60:63], a[184:187], v[144:147], v[60:63]
    v_fma_f32 v139, v139, s31, -v194
    v_cvt_pk_bf16_f32 v1, v2, v3
    v_mfma_f32_16x16x32_bf16 v[60:63], a[188:191], v[152:155], v[60:63]
    v_exp_f32 v139, v139
    v_mul_f32 v13, v196, v13
    v_mul_f32 v14, v196, v14
    v_mfma_f32_16x16x32_bf16 a[196:199], a[208:211], v[144:147], a[196:199]
    v_fma_f32 v140, v140, s31, -v194
    v_mul_f32 v7, v196, v7
    v_mul_f32 v29, v196, v29
    v_mfma_f32_16x16x32_bf16 a[196:199], a[208:211], v[152:155], a[196:199]
    v_exp_f32 v140, v140
    v_mul_f32 v15, v196, v15
    v_cvt_pk_bf16_f32 v9, v10, v11
    v_mfma_f32_16x16x32_bf16 v[144:147], a[64:67], a[48:51], 0
    v_fma_f32 v141, v141, s31, -v194
    v_cvt_pk_bf16_f32 v137, v138, v139
    v_mul_f32 v23, v196, v23
    v_cvt_pk_bf16_f32 v10, v12, v13
    v_mfma_f32_16x16x32_bf16 v[144:147], a[68:71], a[52:55], v[144:147]
    v_exp_f32 v141, v141
    v_cvt_pk_bf16_f32 v26, v28, v29
    v_mfma_f32_16x16x32_bf16 v[144:147], a[72:75], a[56:59], v[144:147]
    v_fma_f32 v142, v142, s31, -v194
    v_mul_f32 v30, v196, v30
    v_cvt_pk_bf16_f32 v11, v14, v15
    v_mfma_f32_16x16x32_bf16 v[144:147], a[76:79], a[60:63], v[144:147]
    v_exp_f32 v142, v142
    v_cvt_pk_bf16_f32 v2, v4, v5
    v_cvt_pk_bf16_f32 v17, v18, v19
    v_mfma_f32_16x16x32_bf16 v[148:151], a[80:83], a[48:51], 0
    v_fma_f32 v143, v143, s31, -v194
    v_cvt_pk_bf16_f32 v138, v140, v141
    v_mul_f32 v31, v196, v31
    v_mfma_f32_16x16x32_bf16 v[148:151], a[84:87], a[52:55], v[148:151]
    v_exp_f32 v143, v143
    v_cvt_pk_bf16_f32 v3, v6, v7
    v_mfma_f32_16x16x32_bf16 v[148:151], a[88:91], a[56:59], v[148:151]
    ds_write_b128 v164, v[0:3]
    v_mfma_f32_16x16x32_bf16 v[148:151], a[92:95], a[60:63], v[148:151]
    ds_write_b128 v165, v[8:11]
    v_mfma_f32_16x16x32_bf16 v[152:155], a[96:99], a[48:51], 0
    v_fma_f32 v144, v144, s31, -v195
    v_cvt_pk_bf16_f32 v139, v142, v143
    v_cvt_pk_bf16_f32 v18, v20, v21
    v_mfma_f32_16x16x32_bf16 v[152:155], a[100:103], a[52:55], v[152:155]
    v_exp_f32 v144, v144
    v_mfma_f32_16x16x32_bf16 v[152:155], a[104:107], a[56:59], v[152:155]
    v_fma_f32 v145, v145, s31, -v195
    v_cvt_pk_bf16_f32 v27, v30, v31
    v_mfma_f32_16x16x32_bf16 v[152:155], a[108:111], a[60:63], v[152:155]
    v_exp_f32 v145, v145
    v_cvt_pk_bf16_f32 v19, v22, v23
    v_mfma_f32_16x16x32_bf16 v[156:159], a[112:115], a[48:51], 0
    v_fma_f32 v146, v146, s31, -v195
    v_cvt_pk_bf16_f32 v144, v144, v145
    v_mfma_f32_16x16x32_bf16 v[156:159], a[116:119], a[52:55], v[156:159]
    v_exp_f32 v146, v146
    v_mfma_f32_16x16x32_bf16 v[156:159], a[120:123], a[56:59], v[156:159]
    ds_write_b128 v166, v[16:19]
    v_fma_f32 v147, v147, s31, -v195
    v_mfma_f32_16x16x32_bf16 v[156:159], a[124:127], a[60:63], v[156:159]
    ds_write_b128 v167, v[24:27]
    v_exp_f32 v147, v147
    v_mfma_f32_16x16x32_bf16 v[64:67], a[128:131], v[128:131], v[64:67]
    ds_read_b128 a[212:215], v190
    v_fma_f32 v148, v148, s31, -v195
    v_cvt_pk_bf16_f32 v145, v146, v147
    v_mfma_f32_16x16x32_bf16 v[64:67], a[132:135], v[136:139], v[64:67]
    ds_read_b128 a[216:219], v190 offset:1024
    v_exp_f32 v148, v148
    v_mfma_f32_16x16x32_bf16 v[68:71], a[136:139], v[128:131], v[68:71]
    ds_read_b128 a[220:223], v190 offset:2048
    ds_read_b128 a[224:227], v190 offset:3072
    v_fma_f32 v149, v149, s31, -v195
    v_mfma_f32_16x16x32_bf16 v[68:71], a[140:143], v[136:139], v[68:71]
    v_exp_f32 v149, v149
    v_mfma_f32_16x16x32_bf16 v[72:75], a[144:147], v[128:131], v[72:75]
    v_fma_f32 v150, v150, s31, -v195
    v_cvt_pk_bf16_f32 v146, v148, v149
    v_mfma_f32_16x16x32_bf16 v[72:75], a[148:151], v[136:139], v[72:75]
    v_exp_f32 v150, v150
    v_mfma_f32_16x16x32_bf16 v[76:79], a[152:155], v[128:131], v[76:79]
    s_waitcnt lgkmcnt(3)
    buffer_store_dwordx4 a[212:215], v184, s[20:23], 0 offen sc1 nt
    v_fma_f32 v151, v151, s31, -v195
    v_mfma_f32_16x16x32_bf16 v[76:79], a[156:159], v[136:139], v[76:79]
    v_exp_f32 v151, v151
    v_mfma_f32_16x16x32_bf16 v[80:83], a[160:163], v[128:131], v[80:83]
    s_waitcnt lgkmcnt(2)
    buffer_store_dwordx4 a[216:219], v185, s[20:23], 0 offen offset:1024 sc1 nt
    v_fma_f32 v152, v152, s31, -v195
    v_cvt_pk_bf16_f32 v147, v150, v151
    v_mfma_f32_16x16x32_bf16 v[80:83], a[164:167], v[136:139], v[80:83]
    v_exp_f32 v152, v152
    v_mfma_f32_16x16x32_bf16 v[84:87], a[168:171], v[128:131], v[84:87]
    s_waitcnt lgkmcnt(1)
    buffer_store_dwordx4 a[220:223], v186, s[20:23], 0 offen offset:2048 sc1 nt
    v_fma_f32 v153, v153, s31, -v195
    v_mfma_f32_16x16x32_bf16 v[84:87], a[172:175], v[136:139], v[84:87]
    v_exp_f32 v153, v153
    v_mfma_f32_16x16x32_bf16 v[88:91], a[176:179], v[128:131], v[88:91]
    v_fma_f32 v154, v154, s31, -v195
    v_cvt_pk_bf16_f32 v152, v152, v153
    v_mfma_f32_16x16x32_bf16 v[88:91], a[180:183], v[136:139], v[88:91]
    v_exp_f32 v154, v154
    v_mfma_f32_16x16x32_bf16 v[92:95], a[184:187], v[128:131], v[92:95]
    s_waitcnt lgkmcnt(0)
    buffer_store_dwordx4 a[224:227], v187, s[20:23], 0 offen offset:3072 sc1 nt
    v_fma_f32 v155, v155, s31, -v195
    v_mfma_f32_16x16x32_bf16 v[92:95], a[188:191], v[136:139], v[92:95]
    v_exp_f32 v155, v155
    v_mfma_f32_16x16x32_bf16 a[200:203], a[208:211], v[128:131], a[200:203]
    v_fma_f32 v156, v156, s31, -v195
    v_cvt_pk_bf16_f32 v153, v154, v155
    v_mfma_f32_16x16x32_bf16 a[200:203], a[208:211], v[136:139], a[200:203]
    v_exp_f32 v156, v156
L_tail:
    v_fma_f32 v157, v157, s31, -v195
    v_exp_f32 v157, v157
    v_fma_f32 v158, v158, s31, -v195
    v_cvt_pk_bf16_f32 v154, v156, v157
    v_exp_f32 v158, v158
    v_fma_f32 v159, v159, s31, -v195
    v_exp_f32 v159, v159
    v_accvgpr_read_b32 v205, a196
    v_accvgpr_read_b32 v206, a200
    v_cvt_pk_bf16_f32 v155, v158, v159
    v_rcp_f32 v198, v205
    v_rcp_f32 v200, v206
    s_nop 0
    v_pk_mul_f32 v[32:33], v[32:33], v[198:199] op_sel_hi:[1,0]
    v_pk_mul_f32 v[34:35], v[34:35], v[198:199] op_sel_hi:[1,0]
    v_pk_mul_f32 v[36:37], v[36:37], v[198:199] op_sel_hi:[1,0]
    v_pk_mul_f32 v[38:39], v[38:39], v[198:199] op_sel_hi:[1,0]
    v_pk_mul_f32 v[40:41], v[40:41], v[198:199] op_sel_hi:[1,0]
    v_pk_mul_f32 v[42:43], v[42:43], v[198:199] op_sel_hi:[1,0]
    v_pk_mul_f32 v[44:45], v[44:45], v[198:199] op_sel_hi:[1,0]
    v_pk_mul_f32 v[46:47], v[46:47], v[198:199] op_sel_hi:[1,0]
    v_cvt_pk_bf16_f32 v32, v32, v33
    v_cvt_pk_bf16_f32 v33, v34, v35
    v_cvt_pk_bf16_f32 v34, v36, v37
    v_cvt_pk_bf16_f32 v35, v38, v39
    v_cvt_pk_bf16_f32 v40, v40, v41
    v_cvt_pk_bf16_f32 v41, v42, v43
    v_cvt_pk_bf16_f32 v42, v44, v45
    v_cvt_pk_bf16_f32 v43, v46, v47
    v_pk_mul_f32 v[48:49], v[48:49], v[198:199] op_sel_hi:[1,0]
    v_pk_mul_f32 v[50:51], v[50:51], v[198:199] op_sel_hi:[1,0]
    v_pk_mul_f32 v[52:53], v[52:53], v[198:199] op_sel_hi:[1,0]
    v_pk_mul_f32 v[54:55], v[54:55], v[198:199] op_sel_hi:[1,0]
    v_pk_mul_f32 v[56:57], v[56:57], v[198:199] op_sel_hi:[1,0]
    v_pk_mul_f32 v[58:59], v[58:59], v[198:199] op_sel_hi:[1,0]
    v_pk_mul_f32 v[60:61], v[60:61], v[198:199] op_sel_hi:[1,0]
    v_pk_mul_f32 v[62:63], v[62:63], v[198:199] op_sel_hi:[1,0]
    v_cvt_pk_bf16_f32 v48, v48, v49
    v_cvt_pk_bf16_f32 v49, v50, v51
    v_cvt_pk_bf16_f32 v50, v52, v53
    v_cvt_pk_bf16_f32 v51, v54, v55
    v_cvt_pk_bf16_f32 v56, v56, v57
    v_cvt_pk_bf16_f32 v57, v58, v59
    v_cvt_pk_bf16_f32 v58, v60, v61
    v_cvt_pk_bf16_f32 v59, v62, v63
    ds_write_b128 v164, v[32:35] offset:4096
    ds_write_b128 v165, v[40:43] offset:4096
    ds_write_b128 v166, v[48:51] offset:4096
    ds_write_b128 v167, v[56:59] offset:4096
    ds_read_b128 a[228:231], v190 offset:4096
    ds_read_b128 a[232:235], v190 offset:5120
    ds_read_b128 a[236:239], v190 offset:6144
    ds_read_b128 a[240:243], v190 offset:7168
    v_pk_mul_f32 v[64:65], v[64:65], v[200:201] op_sel_hi:[1,0]
    v_pk_mul_f32 v[66:67], v[66:67], v[200:201] op_sel_hi:[1,0]
    v_pk_mul_f32 v[68:69], v[68:69], v[200:201] op_sel_hi:[1,0]
    v_pk_mul_f32 v[70:71], v[70:71], v[200:201] op_sel_hi:[1,0]
    v_pk_mul_f32 v[72:73], v[72:73], v[200:201] op_sel_hi:[1,0]
    v_pk_mul_f32 v[74:75], v[74:75], v[200:201] op_sel_hi:[1,0]
    v_pk_mul_f32 v[76:77], v[76:77], v[200:201] op_sel_hi:[1,0]
    v_pk_mul_f32 v[78:79], v[78:79], v[200:201] op_sel_hi:[1,0]
    v_cvt_pk_bf16_f32 v64, v64, v65
    v_cvt_pk_bf16_f32 v65, v66, v67
    v_cvt_pk_bf16_f32 v66, v68, v69
    v_cvt_pk_bf16_f32 v67, v70, v71
    v_cvt_pk_bf16_f32 v72, v72, v73
    v_cvt_pk_bf16_f32 v73, v74, v75
    v_cvt_pk_bf16_f32 v74, v76, v77
    v_cvt_pk_bf16_f32 v75, v78, v79
    v_pk_mul_f32 v[80:81], v[80:81], v[200:201] op_sel_hi:[1,0]
    v_pk_mul_f32 v[82:83], v[82:83], v[200:201] op_sel_hi:[1,0]
    v_pk_mul_f32 v[84:85], v[84:85], v[200:201] op_sel_hi:[1,0]
    v_pk_mul_f32 v[86:87], v[86:87], v[200:201] op_sel_hi:[1,0]
    v_pk_mul_f32 v[88:89], v[88:89], v[200:201] op_sel_hi:[1,0]
    v_pk_mul_f32 v[90:91], v[90:91], v[200:201] op_sel_hi:[1,0]
    v_pk_mul_f32 v[92:93], v[92:93], v[200:201] op_sel_hi:[1,0]
    v_pk_mul_f32 v[94:95], v[94:95], v[200:201] op_sel_hi:[1,0]
    v_cvt_pk_bf16_f32 v80, v80, v81
    v_cvt_pk_bf16_f32 v81, v82, v83
    v_cvt_pk_bf16_f32 v82, v84, v85
    v_cvt_pk_bf16_f32 v83, v86, v87
    v_cvt_pk_bf16_f32 v88, v88, v89
    v_cvt_pk_bf16_f32 v89, v90, v91
    v_cvt_pk_bf16_f32 v90, v92, v93
    v_cvt_pk_bf16_f32 v91, v94, v95
    s_waitcnt lgkmcnt(3)
    buffer_store_dwordx4 a[228:231], v184, s[20:23], s36 offen sc1 nt
    s_waitcnt lgkmcnt(2)
    buffer_store_dwordx4 a[232:235], v185, s[20:23], s36 offen offset:1024 sc1 nt
    s_waitcnt lgkmcnt(1)
    buffer_store_dwordx4 a[236:239], v186, s[20:23], s36 offen offset:2048 sc1 nt
    s_waitcnt lgkmcnt(0)
    buffer_store_dwordx4 a[240:243], v187, s[20:23], s36 offen offset:3072 sc1 nt
    ds_write_b128 v164, v[64:67] offset:8192
    ds_write_b128 v165, v[72:75] offset:8192
    ds_write_b128 v166, v[80:83] offset:8192
    ds_write_b128 v167, v[88:91] offset:8192
    ds_read_b128 a[212:215], v190 offset:8192
    ds_read_b128 a[216:219], v190 offset:9216
    ds_read_b128 a[220:223], v190 offset:10240
    ds_read_b128 a[224:227], v190 offset:11264
    v_mfma_f32_16x16x32_bf16 v[96:99], a[128:131], v[144:147], v[96:99]
    v_mfma_f32_16x16x32_bf16 v[96:99], a[132:135], v[152:155], v[96:99]
    v_mfma_f32_16x16x32_bf16 v[100:103], a[136:139], v[144:147], v[100:103]
    v_mfma_f32_16x16x32_bf16 v[100:103], a[140:143], v[152:155], v[100:103]
    v_mfma_f32_16x16x32_bf16 v[104:107], a[144:147], v[144:147], v[104:107]
    v_mfma_f32_16x16x32_bf16 v[104:107], a[148:151], v[152:155], v[104:107]
    v_mfma_f32_16x16x32_bf16 v[108:111], a[152:155], v[144:147], v[108:111]
    s_waitcnt lgkmcnt(3)
    buffer_store_dwordx4 a[212:215], v184, s[20:23], s37 offen sc1 nt
    v_mfma_f32_16x16x32_bf16 v[108:111], a[156:159], v[152:155], v[108:111]
    s_waitcnt lgkmcnt(2)
    buffer_store_dwordx4 a[216:219], v185, s[20:23], s37 offen offset:1024 sc1 nt
    v_mfma_f32_16x16x32_bf16 v[112:115], a[160:163], v[144:147], v[112:115]
    s_waitcnt lgkmcnt(1)
    buffer_store_dwordx4 a[220:223], v186, s[20:23], s37 offen offset:2048 sc1 nt
    v_mfma_f32_16x16x32_bf16 v[112:115], a[164:167], v[152:155], v[112:115]
    s_waitcnt lgkmcnt(0)
    buffer_store_dwordx4 a[224:227], v187, s[20:23], s37 offen offset:3072 sc1 nt
    v_mfma_f32_16x16x32_bf16 v[116:119], a[168:171], v[144:147], v[116:119]
    v_mfma_f32_16x16x32_bf16 v[116:119], a[172:175], v[152:155], v[116:119]
    v_mfma_f32_16x16x32_bf16 v[120:123], a[176:179], v[144:147], v[120:123]
    v_mfma_f32_16x16x32_bf16 v[120:123], a[180:183], v[152:155], v[120:123]
    v_mfma_f32_16x16x32_bf16 v[124:127], a[184:187], v[144:147], v[124:127]
    v_mfma_f32_16x16x32_bf16 v[124:127], a[188:191], v[152:155], v[124:127]
    v_mfma_f32_16x16x32_bf16 a[204:207], a[208:211], v[144:147], a[204:207]
    v_mfma_f32_16x16x32_bf16 a[204:207], a[208:211], v[152:155], a[204:207]
    s_nop 7
    v_accvgpr_read_b32 v207, a204
    v_rcp_f32 v202, v207
    v_maximum3_f32 v212, v204, v205, v206
    v_maximum3_f32 v212, v212, v207, v207
    v_cmp_ngt_f32 s[40:41], s32, v212
    v_pk_mul_f32 v[96:97], v[96:97], v[202:203] op_sel_hi:[1,0]
    v_pk_mul_f32 v[98:99], v[98:99], v[202:203] op_sel_hi:[1,0]
    v_pk_mul_f32 v[100:101], v[100:101], v[202:203] op_sel_hi:[1,0]
    v_pk_mul_f32 v[102:103], v[102:103], v[202:203] op_sel_hi:[1,0]
    v_pk_mul_f32 v[104:105], v[104:105], v[202:203] op_sel_hi:[1,0]
    v_pk_mul_f32 v[106:107], v[106:107], v[202:203] op_sel_hi:[1,0]
    v_pk_mul_f32 v[108:109], v[108:109], v[202:203] op_sel_hi:[1,0]
    v_pk_mul_f32 v[110:111], v[110:111], v[202:203] op_sel_hi:[1,0]
    v_cvt_pk_bf16_f32 v96, v96, v97
    v_cvt_pk_bf16_f32 v97, v98, v99
    v_cvt_pk_bf16_f32 v98, v100, v101
    v_cvt_pk_bf16_f32 v99, v102, v103
    v_cvt_pk_bf16_f32 v104, v104, v105
    v_cvt_pk_bf16_f32 v105, v106, v107
    v_cvt_pk_bf16_f32 v106, v108, v109
    v_cvt_pk_bf16_f32 v107, v110, v111
    v_pk_mul_f32 v[112:113], v[112:113], v[202:203] op_sel_hi:[1,0]
    v_pk_mul_f32 v[114:115], v[114:115], v[202:203] op_sel_hi:[1,0]
    v_pk_mul_f32 v[116:117], v[116:117], v[202:203] op_sel_hi:[1,0]
    v_pk_mul_f32 v[118:119], v[118:119], v[202:203] op_sel_hi:[1,0]
    v_pk_mul_f32 v[120:121], v[120:121], v[202:203] op_sel_hi:[1,0]
    v_pk_mul_f32 v[122:123], v[122:123], v[202:203] op_sel_hi:[1,0]
    v_pk_mul_f32 v[124:125], v[124:125], v[202:203] op_sel_hi:[1,0]
    v_pk_mul_f32 v[126:127], v[126:127], v[202:203] op_sel_hi:[1,0]
    v_cvt_pk_bf16_f32 v112, v112, v113
    v_cvt_pk_bf16_f32 v113, v114, v115
    v_cvt_pk_bf16_f32 v114, v116, v117
    v_cvt_pk_bf16_f32 v115, v118, v119
    v_cvt_pk_bf16_f32 v120, v120, v121
    v_cvt_pk_bf16_f32 v121, v122, v123
    v_cvt_pk_bf16_f32 v122, v124, v125
    v_cvt_pk_bf16_f32 v123, v126, v127
    ds_write_b128 v164, v[96:99] offset:12288
    ds_write_b128 v165, v[104:107] offset:12288
    ds_write_b128 v166, v[112:115] offset:12288
    ds_write_b128 v167, v[120:123] offset:12288
    ds_read_b128 a[228:231], v190 offset:12288
    ds_read_b128 a[232:235], v190 offset:13312
    ds_read_b128 a[236:239], v190 offset:14336
    ds_read_b128 a[240:243], v190 offset:15360
    s_cmp_lg_u64 s[40:41], 0
    s_cselect_b32 s40, s51, 0
    s_or_b32 s33, s33, s40
    s_and_b32 s22, s22, s35
    s_waitcnt lgkmcnt(3)
    buffer_store_dwordx4 a[228:231], v184, s[20:23], s38 offen sc1 nt
    s_waitcnt lgkmcnt(2)
    buffer_store_dwordx4 a[232:235], v185, s[20:23], s38 offen offset:1024 sc1 nt
    s_waitcnt lgkmcnt(1)
    buffer_store_dwordx4 a[236:239], v186, s[20:23], s38 offen offset:2048 sc1 nt
    s_waitcnt lgkmcnt(0)
    buffer_store_dwordx4 a[240:243], v187, s[20:23], s38 offen offset:3072 sc1 nt
L_slow:
    s_cmp_eq_u32 s33, 0
    s_cbranch_scc1 L_done
    s_waitcnt vmcnt(0)
    v_mbcnt_lo_u32_b32 v208, -1, 0
    v_mbcnt_hi_u32_b32 v208, -1, v208
    v_and_b32 v209, 31, v208
    v_lshrrev_b32 v210, 5, v208
    v_lshlrev_b32 v209, 8, v209
    v_lshl_add_u32 v209, v210, 4, v209
    v_bfe_u32 v213, v208, 2, 2
    v_lshl_add_u32 v214, v210, 2, v213
    v_lshlrev_b32 v214, 8, v214
    v_bfe_u32 v215, v208, 4, 1
    v_lshl_add_u32 v214, v215, 5, v214
    v_and_b32 v215, 1, v208
    v_lshl_add_u32 v214, v215, 4, v214
    v_bfe_u32 v215, v208, 1, 1
    v_lshl_add_u32 v214, v215, 3, v214
    v_add_u32 v214, s34, v214
    v_xor_b32 v215, 0, v213
    v_lshl_add_u32 v160, v215, 6, v214
    v_xor_b32 v215, 1, v213
    v_lshl_add_u32 v161, v215, 6, v214
    v_xor_b32 v215, 2, v213
    v_lshl_add_u32 v162, v215, 6, v214
    v_xor_b32 v215, 3, v213
    v_lshl_add_u32 v163, v215, 6, v214
    v_lshrrev_b32 v213, 4, v208
    v_and_b32 v214, 15, v208
    v_lshlrev_b32 v215, 2, v213
    v_xor_b32 v215, v215, v214
    v_lshlrev_b32 v213, 8, v213
    v_lshl_add_u32 v164, v215, 4, v213
    s_mov_b32 s10, 67108864
    s_mov_b32 s14, 67108864
L_slow_unit:
    s_ff1_i32_b32 s40, s33
    s_bitset0_b32 s33, s40
    s_mul_i32 s40, s40, 16
    s_add_u32 s40, s40, s48
    s_mov_b32 s41, 0
L_slow_blk:
    s_mul_i32 s43, s40, 126976
    s_add_u32 s16, s52, s43
    s_addc_u32 s17, s53, 0
    s_mov_b32 s18, 126976
    s_add_u32 s20, s58, s43
    s_addc_u32 s21, s59, 0
    s_mov_b32 s22, 126976
    s_lshl_b32 s43, s41, 5
    s_add_u32 s43, s43, s49
    s_lshl_b32 s43, s43, 8
    v_add_u32 v210, s43, v209
    buffer_load_dwordx4 a[0:3], v210, s[16:19], 0 offen
    buffer_load_dwordx4 a[4:7], v210, s[16:19], 0 offen offset:32
    buffer_load_dwordx4 a[8:11], v210, s[16:19], 0 offen offset:64
    buffer_load_dwordx4 a[12:15], v210, s[16:19], 0 offen offset:96
    buffer_load_dwordx4 a[16:19], v210, s[16:19], 0 offen offset:128
    buffer_load_dwordx4 a[20:23], v210, s[16:19], 0 offen offset:160
    buffer_load_dwordx4 a[24:27], v210, s[16:19], 0 offen offset:192
    buffer_load_dwordx4 a[28:31], v210, s[16:19], 0 offen offset:224
    v_mov_b32 v211, 0xff800000
    s_mov_b32 s42, 0
L_slow_p1:
    s_lshl_b32 s43, s40, 17
    s_lshl_b32 s44, s42, 13
    s_add_u32 s43, s43, s44
    v_add_u32 v212, s43, v209
    buffer_load_dwordx4 a[64:67], v212, s[8:11], 0 offen
    buffer_load_dwordx4 a[68:71], v212, s[8:11], 0 offen offset:32
    buffer_load_dwordx4 a[72:75], v212, s[8:11], 0 offen offset:64
    buffer_load_dwordx4 a[76:79], v212, s[8:11], 0 offen offset:96
    buffer_load_dwordx4 a[80:83], v212, s[8:11], 0 offen offset:128
    buffer_load_dwordx4 a[84:87], v212, s[8:11], 0 offen offset:160
    buffer_load_dwordx4 a[88:91], v212, s[8:11], 0 offen offset:192
    buffer_load_dwordx4 a[92:95], v212, s[8:11], 0 offen offset:224
    s_waitcnt vmcnt(0)
    v_mfma_f32_32x32x16_bf16 v[128:143], a[64:67], a[0:3], 0
    v_mfma_f32_32x32x16_bf16 v[128:143], a[68:71], a[4:7], v[128:143]
    v_mfma_f32_32x32x16_bf16 v[128:143], a[72:75], a[8:11], v[128:143]
    v_mfma_f32_32x32x16_bf16 v[128:143], a[76:79], a[12:15], v[128:143]
    v_mfma_f32_32x32x16_bf16 v[128:143], a[80:83], a[16:19], v[128:143]
    v_mfma_f32_32x32x16_bf16 v[128:143], a[84:87], a[20:23], v[128:143]
    v_mfma_f32_32x32x16_bf16 v[128:143], a[88:91], a[24:27], v[128:143]
    v_mfma_f32_32x32x16_bf16 v[128:143], a[92:95], a[28:31], v[128:143]
    s_nop 15
    v_max_f32 v211, v211, v128
    v_max_f32 v211, v211, v129
    v_max_f32 v211, v211, v130
    v_max_f32 v211, v211, v131
    v_max_f32 v211, v211, v132
    v_max_f32 v211, v211, v133
    v_max_f32 v211, v211, v134
    v_max_f32 v211, v211, v135
    v_max_f32 v211, v211, v136
    v_max_f32 v211, v211, v137
    v_max_f32 v211, v211, v138
    v_max_f32 v211, v211, v139
    v_max_f32 v211, v211, v140
    v_max_f32 v211, v211, v141
    v_max_f32 v211, v211, v142
    v_max_f32 v211, v211, v143
    s_add_u32 s42, s42, 1
    s_cmp_lt_u32 s42, 16
    s_cbranch_scc1 L_slow_p1
    v_mov_b32 v213, v211
    s_nop 1
    v_permlane32_swap_b32 v211, v213
    v_max_f32 v211, v211, v213
    v_mul_f32 v167, s31, v211
    v_mov_b32 v166, 0
    v_mov_b32 v0, 0
    v_mov_b32 v1, 0
    v_mov_b32 v2, 0
    v_mov_b32 v3, 0
    v_mov_b32 v4, 0
    v_mov_b32 v5, 0
    v_mov_b32 v6, 0
    v_mov_b32 v7, 0
    v_mov_b32 v8, 0
    v_mov_b32 v9, 0
    v_mov_b32 v10, 0
    v_mov_b32 v11, 0
    v_mov_b32 v12, 0
    v_mov_b32 v13, 0
    v_mov_b32 v14, 0
    v_mov_b32 v15, 0
    v_mov_b32 v16, 0
    v_mov_b32 v17, 0
    v_mov_b32 v18, 0
    v_mov_b32 v19, 0
    v_mov_b32 v20, 0
    v_mov_b32 v21, 0
    v_mov_b32 v22, 0
    v_mov_b32 v23, 0
    v_mov_b32 v24, 0
    v_mov_b32 v25, 0
    v_mov_b32 v26, 0
    v_mov_b32 v27, 0
    v_mov_b32 v28, 0
    v_mov_b32 v29, 0
    v_mov_b32 v30, 0
    v_mov_b32 v31, 0
    v_mov_b32 v32, 0
    v_mov_b32 v33, 0
    v_mov_b32 v34, 0
    v_mov_b32 v35, 0
    v_mov_b32 v36, 0
    v_mov_b32 v37, 0
    v_mov_b32 v38, 0
    v_mov_b32 v39, 0
    v_mov_b32 v40, 0
    v_mov_b32 v41, 0
    v_mov_b32 v42, 0
    v_mov_b32 v43, 0
    v_mov_b32 v44, 0
    v_mov_b32 v45, 0
    v_mov_b32 v46, 0
    v_mov_b32 v47, 0
    v_mov_b32 v48, 0
    v_mov_b32 v49, 0
    v_mov_b32 v50, 0
    v_mov_b32 v51, 0
    v_mov_b32 v52, 0
    v_mov_b32 v53, 0
    v_mov_b32 v54, 0
    v_mov_b32 v55, 0
    v_mov_b32 v56, 0
    v_mov_b32 v57, 0
    v_mov_b32 v58, 0
    v_mov_b32 v59, 0
    v_mov_b32 v60, 0
    v_mov_b32 v61, 0
    v_mov_b32 v62, 0
    v_mov_b32 v63, 0
    s_mov_b32 s42, 0
L_slow_p2:
    s_lshl_b32 s43, s40, 17
    s_lshl_b32 s44, s42, 13
    s_add_u32 s45, s43, s44
    s_add_u32 m0, s34, 0
    s_nop 0
    buffer_load_dwordx4 v164, s[12:15], s45 offen lds
    buffer_load_dwordx4 v164, s[12:15], s45 offen offset:1024 lds
    buffer_load_dwordx4 v164, s[12:15], s45 offen offset:2048 lds
    buffer_load_dwordx4 v164, s[12:15], s45 offen offset:3072 lds
    s_add_u32 m0, s34, 4096
    s_add_u32 s45, s45, 4096
    buffer_load_dwordx4 v164, s[12:15], s45 offen lds
    buffer_load_dwordx4 v164, s[12:15], s45 offen offset:1024 lds
    buffer_load_dwordx4 v164, s[12:15], s45 offen offset:2048 lds
    buffer_load_dwordx4 v164, s[12:15], s45 offen offset:3072 lds
    s_lshl_b32 s43, s40, 17
    s_lshl_b32 s44, s42, 13
    s_add_u32 s43, s43, s44
    v_add_u32 v212, s43, v209
    buffer_load_dwordx4 a[64:67], v212, s[8:11], 0 offen
    buffer_load_dwordx4 a[68:71], v212, s[8:11], 0 offen offset:32
    buffer_load_dwordx4 a[72:75], v212, s[8:11], 0 offen offset:64
    buffer_load_dwordx4 a[76:79], v212, s[8:11], 0 offen offset:96
    buffer_load_dwordx4 a[80:83], v212, s[8:11], 0 offen offset:128
    buffer_load_dwordx4 a[84:87], v212, s[8:11], 0 offen offset:160
    buffer_load_dwordx4 a[88:91], v212, s[8:11], 0 offen offset:192
    buffer_load_dwordx4 a[92:95], v212, s[8:11], 0 offen offset:224
    s_waitcnt vmcnt(0)
    v_mfma_f32_32x32x16_bf16 v[128:143], a[64:67], a[0:3], 0
    v_mfma_f32_32x32x16_bf16 v[128:143], a[68:71], a[4:7], v[128:143]
    v_mfma_f32_32x32x16_bf16 v[128:143], a[72:75], a[8:11], v[128:143]
    v_mfma_f32_32x32x16_bf16 v[128:143], a[76:79], a[12:15], v[128:143]
    v_mfma_f32_32x32x16_bf16 v[128:143], a[80:83], a[16:19], v[128:143]
    v_mfma_f32_32x32x16_bf16 v[128:143], a[84:87], a[20:23], v[128:143]
    v_mfma_f32_32x32x16_bf16 v[128:143], a[88:91], a[24:27], v[128:143]
    v_mfma_f32_32x32x16_bf16 v[128:143], a[92:95], a[28:31], v[128:143]
    s_nop 15
    v_fma_f32 v128, v128, s31, -v167
    v_fma_f32 v129, v129, s31, -v167
    v_fma_f32 v130, v130, s31, -v167
    v_fma_f32 v131, v131, s31, -v167
    v_fma_f32 v132, v132, s31, -v167
    v_fma_f32 v133, v133, s31, -v167
    v_fma_f32 v134, v134, s31, -v167
    v_fma_f32 v135, v135, s31, -v167
    v_fma_f32 v136, v136, s31, -v167
    v_fma_f32 v137, v137, s31, -v167
    v_fma_f32 v138, v138, s31, -v167
    v_fma_f32 v139, v139, s31, -v167
    v_fma_f32 v140, v140, s31, -v167
    v_fma_f32 v141, v141, s31, -v167
    v_fma_f32 v142, v142, s31, -v167
    v_fma_f32 v143, v143, s31, -v167
    v_exp_f32 v128, v128
    v_exp_f32 v129, v129
    v_exp_f32 v130, v130
    v_exp_f32 v131, v131
    v_exp_f32 v132, v132
    v_exp_f32 v133, v133
    v_exp_f32 v134, v134
    v_exp_f32 v135, v135
    v_exp_f32 v136, v136
    v_exp_f32 v137, v137
    v_exp_f32 v138, v138
    v_exp_f32 v139, v139
    v_exp_f32 v140, v140
    v_exp_f32 v141, v141
    v_exp_f32 v142, v142
    v_exp_f32 v143, v143
    s_nop 0
    v_add_f32 v166, v166, v128
    v_add_f32 v166, v166, v129
    v_add_f32 v166, v166, v130
    v_add_f32 v166, v166, v131
    v_add_f32 v166, v166, v132
    v_add_f32 v166, v166, v133
    v_add_f32 v166, v166, v134
    v_add_f32 v166, v166, v135
    v_add_f32 v166, v166, v136
    v_add_f32 v166, v166, v137
    v_add_f32 v166, v166, v138
    v_add_f32 v166, v166, v139
    v_add_f32 v166, v166, v140
    v_add_f32 v166, v166, v141
    v_add_f32 v166, v166, v142
    v_add_f32 v166, v166, v143
    v_cvt_pk_bf16_f32 v128, v128, v129
    v_cvt_pk_bf16_f32 v129, v130, v131
    v_cvt_pk_bf16_f32 v130, v132, v133
    v_cvt_pk_bf16_f32 v131, v134, v135
    v_cvt_pk_bf16_f32 v136, v136, v137
    v_cvt_pk_bf16_f32 v137, v138, v139
    v_cvt_pk_bf16_f32 v138, v140, v141
    v_cvt_pk_bf16_f32 v139, v142, v143
    ds_read_b64_tr_b16 a[128:129], v160
    ds_read_b64_tr_b16 a[130:131], v160 offset:2048
    ds_read_b64_tr_b16 a[132:133], v161
    ds_read_b64_tr_b16 a[134:135], v161 offset:2048
    ds_read_b64_tr_b16 a[136:137], v162
    ds_read_b64_tr_b16 a[138:139], v162 offset:2048
    ds_read_b64_tr_b16 a[140:141], v163
    ds_read_b64_tr_b16 a[142:143], v163 offset:2048
    ds_read_b64_tr_b16 a[144:145], v160 offset:4096
    ds_read_b64_tr_b16 a[146:147], v160 offset:6144
    ds_read_b64_tr_b16 a[148:149], v161 offset:4096
    ds_read_b64_tr_b16 a[150:151], v161 offset:6144
    ds_read_b64_tr_b16 a[152:153], v162 offset:4096
    ds_read_b64_tr_b16 a[154:155], v162 offset:6144
    ds_read_b64_tr_b16 a[156:157], v163 offset:4096
    ds_read_b64_tr_b16 a[158:159], v163 offset:6144
    s_waitcnt lgkmcnt(0)
    v_mfma_f32_32x32x16_bf16 v[0:15], a[128:131], v[128:131], v[0:15]
    v_mfma_f32_32x32x16_bf16 v[16:31], a[132:135], v[128:131], v[16:31]
    v_mfma_f32_32x32x16_bf16 v[32:47], a[136:139], v[128:131], v[32:47]
    v_mfma_f32_32x32x16_bf16 v[48:63], a[140:143], v[128:131], v[48:63]
    v_mfma_f32_32x32x16_bf16 v[0:15], a[144:147], v[136:139], v[0:15]
    v_mfma_f32_32x32x16_bf16 v[16:31], a[148:151], v[136:139], v[16:31]
    v_mfma_f32_32x32x16_bf16 v[32:47], a[152:155], v[136:139], v[32:47]
    v_mfma_f32_32x32x16_bf16 v[48:63], a[156:159], v[136:139], v[48:63]
    s_nop 15
    s_add_u32 s42, s42, 1
    s_cmp_lt_u32 s42, 16
    s_cbranch_scc1 L_slow_p2
    v_mov_b32 v213, v166
    s_nop 1
    v_permlane32_swap_b32 v166, v213
    v_add_f32 v166, v166, v213
    v_rcp_f32 v166, v166
    s_nop 0
    v_mul_f32 v0, v166, v0
    v_mul_f32 v1, v166, v1
    v_mul_f32 v2, v166, v2
    v_mul_f32 v3, v166, v3
    v_mul_f32 v4, v166, v4
    v_mul_f32 v5, v166, v5
    v_mul_f32 v6, v166, v6
    v_mul_f32 v7, v166, v7
    v_mul_f32 v8, v166, v8
    v_mul_f32 v9, v166, v9
    v_mul_f32 v10, v166, v10
    v_mul_f32 v11, v166, v11
    v_mul_f32 v12, v166, v12
    v_mul_f32 v13, v166, v13
    v_mul_f32 v14, v166, v14
    v_mul_f32 v15, v166, v15
    v_mul_f32 v16, v166, v16
    v_mul_f32 v17, v166, v17
    v_mul_f32 v18, v166, v18
    v_mul_f32 v19, v166, v19
    v_mul_f32 v20, v166, v20
    v_mul_f32 v21, v166, v21
    v_mul_f32 v22, v166, v22
    v_mul_f32 v23, v166, v23
    v_mul_f32 v24, v166, v24
    v_mul_f32 v25, v166, v25
    v_mul_f32 v26, v166, v26
    v_mul_f32 v27, v166, v27
    v_mul_f32 v28, v166, v28
    v_mul_f32 v29, v166, v29
    v_mul_f32 v30, v166, v30
    v_mul_f32 v31, v166, v31
    v_mul_f32 v32, v166, v32
    v_mul_f32 v33, v166, v33
    v_mul_f32 v34, v166, v34
    v_mul_f32 v35, v166, v35
    v_mul_f32 v36, v166, v36
    v_mul_f32 v37, v166, v37
    v_mul_f32 v38, v166, v38
    v_mul_f32 v39, v166, v39
    v_mul_f32 v40, v166, v40
    v_mul_f32 v41, v166, v41
    v_mul_f32 v42, v166, v42
    v_mul_f32 v43, v166, v43
    v_mul_f32 v44, v166, v44
    v_mul_f32 v45, v166, v45
    v_mul_f32 v46, v166, v46
    v_mul_f32 v47, v166, v47
    v_mul_f32 v48, v166, v48
    v_mul_f32 v49, v166, v49
    v_mul_f32 v50, v166, v50
    v_mul_f32 v51, v166, v51
    v_mul_f32 v52, v166, v52
    v_mul_f32 v53, v166, v53
    v_mul_f32 v54, v166, v54
    v_mul_f32 v55, v166, v55
    v_mul_f32 v56, v166, v56
    v_mul_f32 v57, v166, v57
    v_mul_f32 v58, v166, v58
    v_mul_f32 v59, v166, v59
    v_mul_f32 v60, v166, v60
    v_mul_f32 v61, v166, v61
    v_mul_f32 v62, v166, v62
    v_mul_f32 v63, v166, v63
    v_cvt_pk_bf16_f32 v0, v0, v1
    v_cvt_pk_bf16_f32 v1, v2, v3
    v_cvt_pk_bf16_f32 v2, v4, v5
    v_cvt_pk_bf16_f32 v3, v6, v7
    buffer_store_dwordx4 v[0:3], v210, s[20:23], 0 offen
    v_cvt_pk_bf16_f32 v8, v8, v9
    v_cvt_pk_bf16_f32 v9, v10, v11
    v_cvt_pk_bf16_f32 v10, v12, v13
    v_cvt_pk_bf16_f32 v11, v14, v15
    buffer_store_dwordx4 v[8:11], v210, s[20:23], 0 offen offset:32
    v_cvt_pk_bf16_f32 v16, v16, v17
    v_cvt_pk_bf16_f32 v17, v18, v19
    v_cvt_pk_bf16_f32 v18, v20, v21
    v_cvt_pk_bf16_f32 v19, v22, v23
    buffer_store_dwordx4 v[16:19], v210, s[20:23], 0 offen offset:64
    v_cvt_pk_bf16_f32 v24, v24, v25
    v_cvt_pk_bf16_f32 v25, v26, v27
    v_cvt_pk_bf16_f32 v26, v28, v29
    v_cvt_pk_bf16_f32 v27, v30, v31
    buffer_store_dwordx4 v[24:27], v210, s[20:23], 0 offen offset:96
    v_cvt_pk_bf16_f32 v32, v32, v33
    v_cvt_pk_bf16_f32 v33, v34, v35
    v_cvt_pk_bf16_f32 v34, v36, v37
    v_cvt_pk_bf16_f32 v35, v38, v39
    buffer_store_dwordx4 v[32:35], v210, s[20:23], 0 offen offset:128
    v_cvt_pk_bf16_f32 v40, v40, v41
    v_cvt_pk_bf16_f32 v41, v42, v43
    v_cvt_pk_bf16_f32 v42, v44, v45
    v_cvt_pk_bf16_f32 v43, v46, v47
    buffer_store_dwordx4 v[40:43], v210, s[20:23], 0 offen offset:160
    v_cvt_pk_bf16_f32 v48, v48, v49
    v_cvt_pk_bf16_f32 v49, v50, v51
    v_cvt_pk_bf16_f32 v50, v52, v53
    v_cvt_pk_bf16_f32 v51, v54, v55
    buffer_store_dwordx4 v[48:51], v210, s[20:23], 0 offen offset:192
    v_cvt_pk_bf16_f32 v56, v56, v57
    v_cvt_pk_bf16_f32 v57, v58, v59
    v_cvt_pk_bf16_f32 v58, v60, v61
    v_cvt_pk_bf16_f32 v59, v62, v63
    buffer_store_dwordx4 v[56:59], v210, s[20:23], 0 offen offset:224
    s_waitcnt vmcnt(0)
    s_add_u32 s41, s41, 1
    s_cmp_lt_u32 s41, 2
    s_cbranch_scc1 L_slow_blk
    s_cmp_lg_u32 s33, 0
    s_cbranch_scc1 L_slow_unit
L_done:
L_end:
    s_endpgm
.section .rodata,"a"
.p2align 6
.amdhsa_kernel standalone__mha_softmax__near_ridge_kernel
  .amdhsa_next_free_vgpr 500
  .amdhsa_next_free_sgpr 100
  .amdhsa_accum_offset 256
  .amdhsa_group_segment_fixed_size 0
  .amdhsa_kernarg_size 48
  .amdhsa_user_sgpr_count 2
  .amdhsa_user_sgpr_kernarg_segment_ptr 1
  .amdhsa_system_sgpr_workgroup_id_x 1
  .amdhsa_float_denorm_mode_32 3
.end_amdhsa_kernel
```
